```python
import torch

def _softmax(x, axis=-1):
    return torch.softmax(x, dim=axis)
def _gelu(x):
    return torch.nn.functional.gelu(x, approximate="tanh")
def _silu(x):
    return torch.nn.functional.silu(x)
def _sigmoid(x):
    return torch.sigmoid(x)
def _layernorm(x, axis=-1, eps=1e-5):
    m = x.mean(dim=axis, keepdim=True)
    v = x.var(dim=axis, keepdim=True, unbiased=False)
    return (x - m) / torch.sqrt(v + eps)
def _scatter_add(tgt, idx, src, axis=0):
    return tgt.clone().index_add_(axis, idx, src)
def _segment_sum(src, seg, n):
    out = torch.zeros((n,) + src.shape[1:], dtype=src.dtype)
    return out.index_add_(0, seg, src)
def _pad(x, pw):
    flat = tuple(v for pair in reversed(pw) for v in pair)
    return torch.nn.functional.pad(x, flat)

kernel_name = 'interleave_layers__ssm_conv_h3__dense_activation_silu__prompt'

def setup_inputs():

    _w = (lambda a: (lambda t: t.to(torch.bfloat16) if t.is_floating_point() else t)(torch.as_tensor(a)))
    def _A_setup():
        B, S, D = 1, 2048, 512
        ks = 4
        return {
            "q": _w((lambda *s: torch.randn(*s, dtype=torch.bfloat16) * 0.05)(B, S, D)),
            "k": _w((lambda *s: torch.randn(*s, dtype=torch.bfloat16) * 0.2)(B, S, D)),
            "v": _w((lambda *s: torch.randn(*s, dtype=torch.bfloat16) * 0.2)(B, S, D)),
            "shift_k": _w((lambda *s: torch.randn(*s, dtype=torch.bfloat16) * 0.2)(D, ks) * 0.5),
            "ssm_k": _w((lambda *s: torch.randn(*s, dtype=torch.bfloat16) * 0.4)(D, S) * (1.0 / S ** 0.5)),
            "ssm_D": _w((lambda *s: torch.randn(*s, dtype=torch.bfloat16) * 0.2)(D)),
        }
    _A_in = _A_setup()

    def _B_setup():
        B, S, D, F = 1, 2048, 512, 1792
        return {
            "x": _w((lambda *s: torch.randn(*s, dtype=torch.bfloat16) * 0.05)(B, S, D)),
            "w1": _w((lambda *s: torch.randn(*s, dtype=torch.bfloat16) * 0.8)(D, F) * (D ** -0.5)),
            "w2": _w((lambda *s: torch.randn(*s, dtype=torch.bfloat16) * 0.1)(F, D) * (F ** -0.5)),
        }
    _B_in = _B_setup()

    return {
        "A_q": _A_in["q"],
        "A_k": _A_in["k"],
        "A_v": _A_in["v"],
        "A_shift_k": _A_in["shift_k"],
        "A_ssm_k": _A_in["ssm_k"],
        "A_ssm_D": _A_in["ssm_D"],
        "B_x": _B_in["x"],
        "B_w1": _B_in["w1"],
        "B_w2": _B_in["w2"],
    }

def reference(A_q, A_k, A_v, A_shift_k, A_ssm_k, A_ssm_D, B_x, B_w1, B_w2):
    def _A_ref(q, k, v, shift_k, ssm_k, ssm_D):
        B, S, D = q.shape
        ks = shift_k.shape[-1]
        k_pad = _pad(k, ((0, 0), (ks - 1, 0), (0, 0)))
        k_shift = torch.zeros_like(k)
        for t in range(ks):
            k_shift = k_shift + k_pad[:, t:t + S, :] * shift_k[:, ks - 1 - t][None, None, :]
        kv = k_shift * v
        L = 2 * S
        kv_pad = _pad(kv, ((0, 0), (0, S), (0, 0)))
        kf_pad = _pad(ssm_k, ((0, 0), (0, S)))
        kv_f = (lambda x, axes=(-2,-1): torch.fft.rfft2(x.float(), dim=axes))(kv_pad[:, None, :, :], axes=(1, 2))
        kf_f = (lambda x, axes=(-2,-1): torch.fft.rfft2(x.float(), dim=axes))(kf_pad[:, None, :], axes=(1, 2))
        kf_f = (lambda x, *d: x.permute(*d))(kf_f, 1, 2, 0)
        y_f = kv_f * kf_f[None, :, :, :]
        y = (lambda x, s, axes=(-2,-1): torch.fft.irfft2(x, s=s, dim=axes).to(torch.bfloat16))(y_f, (1, L), axes=(1, 2))[:, 0, :S, :]
        y = y + kv * ssm_D[None, None, :]
        return q * y

    def _B_ref(x, w1, w2):
        h = torch.einsum("bsd,df->bsf", x, w1)
        h = _silu(h)
        out = torch.einsum("bsf,fd->bsd", h, w2)
        return out

    x = A_q
    x = x + _A_ref(_layernorm(x, axis=-1), A_k, A_v, A_shift_k, A_ssm_k, A_ssm_D)
    x = x + _B_ref(_layernorm(x, axis=-1), B_w1, B_w2)
    x = x + _A_ref(_layernorm(x, axis=-1), A_k, A_v, A_shift_k, A_ssm_k, A_ssm_D)
    x = x + _B_ref(_layernorm(x, axis=-1), B_w1, B_w2)
    return x
```

```asm
; @launch grid=(256,1,1) block=(256,1,1) lds=162304
.amdgcn_target "amdgcn-amd-amdhsa--gfx950"
.text
.globl interleave_layers__ssm_conv_h3__dense_activation_silu__prompt_kernel
.p2align 8
.type interleave_layers__ssm_conv_h3__dense_activation_silu__prompt_kernel,@function
interleave_layers__ssm_conv_h3__dense_activation_silu__prompt_kernel:
    s_cmp_ge_u32 s2, 256
    s_cbranch_scc1 L2_end
    s_load_dwordx16 s[48:63], s[0:1], 0
    s_load_dwordx8 s[64:71], s[0:1], 64
    s_getpc_b64 s[96:97]
L5_pc:
    s_lshr_b32 s37, s2, 3
    s_mul_i32 s42, s37, 1280
    v_mad_u32_u24 v128, v0, 5, s42
    v_and_b32 v128, -4, v128
    v_min_u32 v128, L3_codeend-L5_pc-4, v128
    global_load_dword v123, v128, s[96:97]
    v_lshrrev_b32 v30, 6, v0
    v_and_b32 v31, 63, v0
    v_readfirstlane_b32 s3, v30
    s_and_b32 s36, s2, 7
    v_lshrrev_b32 v129, 3, v31
    s_lshl_b32 s42, s37, 3
    s_add_u32 s42, s42, s3
    s_lshl_b32 s42, s42, 13
    s_lshl_b32 s43, s36, 7
    s_add_u32 s42, s42, s43
    v_lshl_add_u32 v128, v129, 10, s42
    v_bfe_u32 v39, v31, 4, 1
    v_lshlrev_b32 v130, 1, v39
    s_add_u32 s43, s3, 1
    s_and_b32 s43, s43, 1
    s_lshl_b32 s43, s43, 2
    v_and_b32 v131, 7, v31
    v_xor_b32 v130, v130, v131
    v_xor_b32 v130, s43, v130
    v_lshl_add_u32 v128, v130, 4, v128
    v_subrev_u32 v130, 0x4000, v128
    v_lshlrev_b32 v1, 4, v31
    s_mov_b32 s6, 0x200000
    s_mov_b32 s7, 0x20000
    s_mov_b32 s10, 0x200000
    s_mov_b32 s11, 0x20000
    s_mov_b32 s34, 0x2000000
    s_mov_b32 s35, 0x20000
    s_mov_b32 s44, 0x8000
    s_lshl_b32 s90, s3, 10
    s_add_u32 m0, s90, 47104
    s_waitcnt lgkmcnt(0)
    s_mov_b64 s[4:5], s[50:51]
    s_mov_b64 s[8:9], s[52:53]
    buffer_load_dwordx4 v128, s[4:7], 0 offen  lds
    s_add_u32 m0, s90, 75776
    s_movk_i32 s14, 4096
    buffer_load_dwordx4 v128, s[8:11], 0 offen  lds
    s_add_u32 m0, s90, 51200
    s_mov_b32 s15, 0x20000
    buffer_load_dwordx4 v128, s[4:7], s44 offen  lds
    s_add_u32 m0, s90, 79872
    s_cmp_lg_u32 s3, 1
    buffer_load_dwordx4 v128, s[8:11], s44 offen  lds
    s_cbranch_scc1 L5_nohalo
    s_mov_b32 m0, 46080
    s_nop 0
    buffer_load_dwordx4 v130, s[4:7], 0 offen lds
L5_nohalo:
    s_mov_b64 s[12:13], s[54:55]
    s_mov_b64 s[32:33], s[70:71]
    s_mov_b64 s[24:25], s[56:57]
    s_mov_b64 s[28:29], s[68:69]
    s_mov_b64 s[16:17], s[48:49]
    s_mov_b64 s[20:21], s[66:67]
    s_mov_b64 s[4:5], s[62:63]
    s_mov_b64 s[8:9], s[64:65]
    s_getreg_b32 s41, hwreg(HW_REG_XCC_ID)
    v_and_b32 v198, 15, v31
    s_lshl_b32 s42, s36, 6
    s_lshl_b32 s43, s3, 4
    s_add_u32 s42, s42, s43
    v_add_u32 v132, s42, v198
    v_lshlrev_b32 v133, 3, v132
    buffer_load_dwordx2 v[134:135], v133, s[12:15], 0 offen
    s_lshl_b32 s45, s37, 2
    s_add_u32 s45, s45, s3
    s_lshl_b32 s86, s36, 12
    s_add_u32 s86, s86, 10485760
    v_mov_b32 v40, 0
    v_mov_b32 v41, 0
    v_mov_b32 v42, 0
    v_mov_b32 v43, 0
    s_cmp_lg_u32 s45, 0
    s_cselect_b32 s78, 0x400, s36
    s_cbranch_scc1 L5_nolead0
    s_add_u32 s42, s86, 32768
    buffer_store_dwordx4 v[40:43], v1, s[32:35], s86 offen offset:2048
    buffer_store_dwordx4 v[40:43], v1, s[32:35], s86 offen
    buffer_store_dwordx4 v[40:43], v1, s[32:35], s86 offen offset:1024
    buffer_store_dwordx4 v[40:43], v1, s[32:35], s42 offen sc1
    buffer_store_dwordx4 v[40:43], v1, s[32:35], s42 offen offset:1024 sc1
L5_nolead0:
    s_lshl_b32 s78, s78, 2
    s_lshl_b32 s40, s36, 5
    s_add_u32 s40, s40, s37
    s_lshl_b32 s88, s40, 13
    v_lshlrev_b32 v137, 5, v0
    s_add_u32 s92, s88, 0
    s_add_u32 s89, s88, 4096
    v_lshlrev_b32 v192, 4, v0
    v_subrev_u32 v193, 8, v192
    v_cmp_eq_u32 vcc, 0, v0
    v_cmp_ne_u32 s[42:43], 0, v31
    v_mov_b32 v194, 0x40000000
    s_or_b64 vcc, vcc, s[42:43]
    s_mov_b32 s26, 0x200000
    s_mov_b32 s27, 0x20000
    v_cndmask_b32 v193, v193, v194, vcc
    v_mov_b32 v88, -1
    v_mov_b32 v89, -1
    v_mov_b32 v90, -1
    v_mov_b32 v91, -1
    s_add_u32 s52, s88, 6291456
    s_add_u32 s53, s89, 6291456
    s_lshl_b32 s91, s40, 2
    s_mov_b32 s6, 0x1c0000
    s_mov_b32 s10, 0x1c0000
    v_min_u32 v119, 55, v31
    v_lshlrev_b32 v119, 5, v119
    s_mul_i32 s74, s3, 1792
    v_add_u32 v119, s74, v119
    s_mul_i32 s76, s2, 7168
    s_and_b32 s74, s37, 7
    s_lshl_b32 s74, s74, 5
    s_lshr_b32 s75, s40, 3
    s_add_u32 s74, s74, s75
    s_mul_i32 s77, s2, 7168
    s_movk_i32 s30, 256
    s_mov_b32 s31, 0x20000
    v_and_b32 v118, 31, v31
    v_lshlrev_b32 v118, 2, v118
    buffer_load_dwordx4 v[202:205], v192, s[24:27], s88 offen
    buffer_load_dwordx2 v[200:201], v193, s[24:27], s88 offen
    buffer_load_dwordx4 v[210:213], v192, s[24:27], s89 offen
    buffer_load_dwordx2 v[208:209], v193, s[24:27], s89 offen
    s_lshr_b32 s38, s40, 3
    s_and_b32 s39, s37, 7
    s_and_b32 s41, s41, 15
    s_or_b32 s41, s41, 0x80
    s_mul_i32 s46, s41, 0x01010101
    s_mov_b32 s72, 0x01010101
    s_mov_b32 s48, 0
    s_mov_b32 s70, 0xffff0000
    s_mov_b32 s71, 0xffff
    s_add_u32 s82, s86, s45
    s_add_u32 s93, s92, 64
    s_lshl_b32 s42, s37, 8
    s_sub_u32 s73, 7936, s42
    s_mul_i32 s79, s3, 28672
    s_add_u32 s79, s79, 47104
    v_lshrrev_b32 v195, 2, v0
    v_lshlrev_b32 v195, 7, v195
    v_and_b32 v38, 3, v0
    v_lshl_add_u32 v195, v38, 4, v195
    v_and_b32 v34, 1, v31
    v_bfe_u32 v36, v31, 1, 1
    v_bfe_u32 v48, v31, 2, 2
    v_bfe_u32 v49, v31, 3, 1
    v_lshrrev_b32 v35, 5, v31
    v_lshrrev_b32 v199, 4, v31
    v_lshl_add_u32 v142, v199, 3, v48
    v_lshlrev_b32 v142, 7, v142
    s_lshl_b32 s42, s3, 1
    v_add_u32 v139, s42, v36
    v_lshlrev_b32 v140, 1, v49
    v_xor_b32 v139, v139, v140
    v_lshlrev_b32 v140, 2, v39
    v_xor_b32 v139, v139, v140
    v_lshl_add_u32 v139, v139, 4, v142
    v_lshl_add_u32 v139, v34, 3, v139
    v_add_u32 v139, 46592, v139
    v_xor_b32 v138, 64, v139
    v_add_u32 v138, 512, v138
    v_lshrrev_b32 v140, 1, v132
    v_lshlrev_b32 v140, 13, v140
    v_lshl_add_u32 v140, v34, 6, v140
    v_sub_u32 v145, 3, v199
    v_lshl_add_u32 v140, v145, 4, v140
    v_mul_u32_u24 v50, 4608, v35
    v_lshl_add_u32 v50, v118, 2, v50
    v_add_u32 v50, 37376, v50
    v_bfe_u32 v51, v31, 1, 3
    v_mul_u32_u24 v51, 4160, v51
    v_lshl_add_u32 v51, v34, 4, v51
    v_add_u32 v51, 32, v51
    v_cmp_gt_u32 vcc, 64, v0
    v_sub_u32 v46, 15, v198
    v_and_b32 v47, 3, v46
    v_cndmask_b32 v50, v51, v50, vcc
    ds_write_b128 v50, v[40:43]
    v_mov_b32 v0, s41
    v_mul_u32_u24 v196, 4160, v47
    v_lshrrev_b32 v46, 2, v46
    v_lshlrev_b32 v46, 3, v46
    v_sub_u32 v196, v196, v46
    v_lshl_add_u32 v196, v199, 4, v196
    s_lshr_b32 s50, s3, 1
    s_and_b32 s51, s3, 1
    s_lshl_b32 s43, s51, 8
    s_mul_i32 s95, s50, 16640
    s_add_u32 s95, s95, s43
    s_add_u32 s95, s95, 64
    v_add_u32 v196, s95, v196
    s_mul_i32 s95, s50, 4608
    s_add_u32 s95, s95, s43
    s_add_u32 s95, s95, 33760
    v_lshlrev_b32 v197, 5, v198
    v_sub_u32 v197, s95, v197
    v_lshl_add_u32 v197, v199, 4, v197
    v_bfe_u32 v37, v31, 2, 3
    v_lshl_add_u32 v32, v37, 1, v34
    v_lshl_add_u32 v33, v35, 1, v36
    s_lshl_b32 s42, s3, 8
    s_add_u32 s42, s88, s42
    v_lshlrev_b32 v10, 11, v33
    v_lshrrev_b32 v46, 2, v32
    v_lshl_add_u32 v10, v46, 6, v10
    v_and_b32 v46, 2, v32
    v_lshl_add_u32 v10, v46, 3, v10
    v_lshl_add_u32 v10, v34, 5, v10
    v_add_u32 v10, s42, v10
    v_mul_u32_u24 v7, 65536, v49
    v_and_b32 v46, 1, v37
    v_lshl_add_u32 v7, v46, 12, v7
    v_lshl_add_u32 v7, v38, 5, v7
    v_lshl_add_u32 v7, v35, 7, v7
    v_lshl_add_u32 v7, v39, 4, v7
    v_lshlrev_b32 v8, 7, v37
    v_lshl_add_u32 v8, v33, 5, v8
    v_lshl_add_u32 v8, v34, 4, v8
    s_lshl_b32 s42, s51, 10
    v_add_u32 v2, s42, v1
    v_xor_b32 v2, 1024, v2
    v_lshlrev_b32 v3, 2, v131
    s_lshl_b32 s42, s3, 11
    s_add_u32 s42, s42, 32768
    v_add_u32 v4, s42, v2
    s_lshl_b32 s42, s50, 11
    s_lshl_b32 s43, s51, 3
    s_add_u32 s42, s42, s43
    s_add_u32 s42, s42, 40960
    v_add_u32 v5, s42, v2
    s_lshl_b32 s42, s50, 3
    s_add_u32 s42, s42, 45056
    v_add_u32 v6, s42, v2
    v_xor_b32 v6, 1024, v6
    v_lshrrev_b32 v46, 2, v32
    v_lshlrev_b32 v9, 11, v46
    v_and_b32 v46, 3, v32
    v_lshl_add_u32 v9, v46, 8, v9
    v_lshl_add_u32 v9, v33, 4, v9
    s_lshl_b32 s55, s3, 13
    s_lshr_b32 s43, s39, 2
    s_lshl_b32 s43, s43, 10
    s_add_u32 s42, s55, s43
    s_and_b32 s43, s39, 3
    s_lshl_b32 s43, s43, 6
    s_add_u32 s42, s42, s43
    v_add_u32 v9, s42, v9
    v_lshlrev_b32 v12, 6, v33
    v_add_u32 v12, 161792, v12
    s_lshl_b32 s42, s3, 4
    v_add_u32 v11, s42, v12
    v_lshl_add_u32 v11, v39, 2, v11
    v_and_b32 v46, 13, v31
    v_lshl_add_u32 v11, v46, 20, v11
    v_lshlrev_b32 v117, 6, v32
    v_lshl_add_u32 v117, v33, 3, v117
    v_mul_u32_u24 v112, 3584, v129
    v_lshlrev_b32 v46, 1, v199
    v_xor_b32 v46, v46, v131
    v_lshl_add_u32 v112, v46, 4, v112
    v_lshlrev_b32 v124, 10, v129
    v_lshl_add_u32 v124, v46, 4, v124
    s_mul_i32 s42, s39, 448
    s_mul_i32 s43, s50, 224
    s_add_u32 s42, s42, s43
    s_mul_i32 s43, s51, 96
    s_add_u32 s42, s42, s43
    v_add_u32 v112, s42, v112
    v_lshl_add_u32 v46, v39, 2, v48
    v_lshlrev_b32 v47, 7, v46
    v_lshl_add_u32 v47, v35, 10, v47
    v_lshl_add_u32 v47, v34, 3, v47
    v_and_b32 v46, 6, v46
    v_add_u32 v46, v46, v36
    v_lshl_add_u32 v47, v46, 4, v47
    v_add_u32 v47, s79, v47
    s_add_u32 s42, s51, 0
    s_and_b32 s42, s42, 3
    s_lshl_b32 s42, s42, 5
    v_xor_b32 v113, s42, v47
    s_add_u32 s42, s51, 1
    s_and_b32 s42, s42, 3
    s_lshl_b32 s42, s42, 5
    v_xor_b32 v114, s42, v47
    s_add_u32 s42, s51, 2
    s_and_b32 s42, s42, 3
    s_lshl_b32 s42, s42, 5
    v_xor_b32 v115, s42, v47
    s_add_u32 s42, s51, 3
    s_and_b32 s42, s42, 3
    s_lshl_b32 s42, s42, 5
    v_xor_b32 v116, s42, v47
    s_mul_i32 s42, s39, 229376
    s_lshl_b32 s43, s3, 8
    s_add_u32 s42, s42, s43
    v_add_u32 v124, s42, v124
    v_mov_b32 v13, v47
    v_xor_b32 v127, 32, v47
    v_xor_b32 v125, 64, v47
    v_xor_b32 v122, 96, v47
    s_mov_b32 s18, 0x200000
    s_mov_b32 s19, 0x20000
    s_mov_b32 s22, 0x200000
    s_mov_b32 s23, 0x20000
    v_lshrrev_b32 v120, 2, v1
    buffer_load_dword v123, v120, s[32:35], s86 offen offset:2048 sc1
    buffer_load_ubyte v123, off, s[28:31], s36 sc1
    buffer_load_dword v123, v119, s[4:7], s76 offen
    s_cmp_lg_u32 s45, 0
    s_cbranch_scc1 L5_nolead1
    s_waitcnt vmcnt(9)
    buffer_store_byte v0, off, s[28:31], s36
L5_nolead1:
    s_mov_b64 exec, 0
    s_cmp_eq_u32 s3, 0
    s_cbranch_scc1 LP_0
    s_cmp_eq_u32 s3, 1
    s_cbranch_scc1 LP_2
    s_cmp_eq_u32 s3, 2
    s_cbranch_scc1 LP_4
    s_branch LP_6
.p2align 12
LP_7:
LP_back:
    s_mov_b64 exec, -1
    s_waitcnt vmcnt(7) lgkmcnt(0)
    s_barrier
    ds_read_b64_tr_b16 v[32:33], v139 offset:0
    ds_read_b64_tr_b16 v[34:35], v138 offset:0
    ds_read_b64_tr_b16 v[36:37], v138 offset:512
    ds_read_b64_tr_b16 v[38:39], v138 offset:28672
    ds_read_b64_tr_b16 v[40:41], v138 offset:29184
    ds_read_b64_tr_b16 v[48:49], v139 offset:4096
    ds_read_b64_tr_b16 v[50:51], v138 offset:4096
    ds_read_b64_tr_b16 v[52:53], v138 offset:4608
    ds_read_b64_tr_b16 v[54:55], v138 offset:32768
    ds_read_b64_tr_b16 v[56:57], v138 offset:33280
    v_alignbit_b32 v148, v134, v134, 16
    v_alignbit_b32 v149, v135, v135, 16
    v_and_b32 v150, s71, v134
    v_bfi_b32 v151, s71, v135, v134
    v_and_b32 v152, s70, v135
    s_waitcnt lgkmcnt(7)
    v_dot2_f32_bf16 v64, v34, v150, 0
    v_dot2_f32_bf16 v65, v34, v148, 0
    v_dot2_f32_bf16 v66, v35, v150, 0
    v_dot2_f32_bf16 v67, v35, v148, 0
    v_dot2_f32_bf16 v68, v36, v150, 0
    v_dot2_f32_bf16 v69, v36, v148, 0
    v_dot2_f32_bf16 v70, v37, v150, 0
    v_dot2_f32_bf16 v71, v37, v148, 0
    v_dot2_f32_bf16 v64, v33, v151, v64
    v_dot2_f32_bf16 v65, v33, v149, v65
    v_dot2_f32_bf16 v66, v34, v151, v66
    v_dot2_f32_bf16 v67, v34, v149, v67
    v_dot2_f32_bf16 v68, v35, v151, v68
    v_dot2_f32_bf16 v69, v35, v149, v69
    v_dot2_f32_bf16 v70, v36, v151, v70
    v_dot2_f32_bf16 v71, v36, v149, v71
    v_dot2_f32_bf16 v64, v32, v152, v64
    v_dot2_f32_bf16 v66, v33, v152, v66
    v_dot2_f32_bf16 v68, v34, v152, v68
    v_dot2_f32_bf16 v70, v35, v152, v70
    s_waitcnt lgkmcnt(5)
    v_lshlrev_b32 v72, 16, v38
    v_and_b32 v73, s70, v38
    v_lshlrev_b32 v74, 16, v39
    v_and_b32 v75, s70, v39
    v_lshlrev_b32 v76, 16, v40
    v_and_b32 v77, s70, v40
    v_lshlrev_b32 v78, 16, v41
    v_and_b32 v79, s70, v41
    v_pk_mul_f32 v[64:65], v[64:65], v[72:73]
    v_pk_mul_f32 v[66:67], v[66:67], v[74:75]
    v_pk_mul_f32 v[68:69], v[68:69], v[76:77]
    v_pk_mul_f32 v[70:71], v[70:71], v[78:79]
    v_cvt_pk_bf16_f32 v83, v65, v64
    v_cvt_pk_bf16_f32 v82, v67, v66
    v_cvt_pk_bf16_f32 v81, v69, v68
    v_cvt_pk_bf16_f32 v80, v71, v70
    buffer_store_dwordx4 v[80:83], v140, s[32:35], s73 offen offset:128 sc1
    s_waitcnt lgkmcnt(2)
    v_dot2_f32_bf16 v64, v50, v150, 0
    v_dot2_f32_bf16 v65, v50, v148, 0
    v_dot2_f32_bf16 v66, v51, v150, 0
    v_dot2_f32_bf16 v67, v51, v148, 0
    v_dot2_f32_bf16 v68, v52, v150, 0
    v_dot2_f32_bf16 v69, v52, v148, 0
    v_dot2_f32_bf16 v70, v53, v150, 0
    v_dot2_f32_bf16 v71, v53, v148, 0
    v_dot2_f32_bf16 v64, v49, v151, v64
    v_dot2_f32_bf16 v65, v49, v149, v65
    v_dot2_f32_bf16 v66, v50, v151, v66
    v_dot2_f32_bf16 v67, v50, v149, v67
    v_dot2_f32_bf16 v68, v51, v151, v68
    v_dot2_f32_bf16 v69, v51, v149, v69
    v_dot2_f32_bf16 v70, v52, v151, v70
    v_dot2_f32_bf16 v71, v52, v149, v71
    v_dot2_f32_bf16 v64, v48, v152, v64
    v_dot2_f32_bf16 v66, v49, v152, v66
    v_dot2_f32_bf16 v68, v50, v152, v68
    v_dot2_f32_bf16 v70, v51, v152, v70
    s_waitcnt lgkmcnt(0)
    v_lshlrev_b32 v72, 16, v54
    v_and_b32 v73, s70, v54
    v_lshlrev_b32 v74, 16, v55
    v_and_b32 v75, s70, v55
    v_lshlrev_b32 v76, 16, v56
    v_and_b32 v77, s70, v56
    v_lshlrev_b32 v78, 16, v57
    v_and_b32 v79, s70, v57
    v_pk_mul_f32 v[64:65], v[64:65], v[72:73]
    v_pk_mul_f32 v[66:67], v[66:67], v[74:75]
    v_pk_mul_f32 v[68:69], v[68:69], v[76:77]
    v_pk_mul_f32 v[70:71], v[70:71], v[78:79]
    v_cvt_pk_bf16_f32 v87, v65, v64
    v_cvt_pk_bf16_f32 v86, v67, v66
    v_cvt_pk_bf16_f32 v85, v69, v68
    v_cvt_pk_bf16_f32 v84, v71, v70
    buffer_load_ubyte v123, off, s[28:31], s36 sc1
    buffer_store_dwordx4 v[84:87], v140, s[32:35], s73 offen offset:0 sc1
    s_load_dword s94, s[58:59], s91
    s_add_u32 m0, s79, 8192
    s_mov_b32 s80, 0
    buffer_load_dwordx4 v112, s[4:7], s80 offen offset:0 lds
    s_mov_b32 s80, 27648
    buffer_load_dwordx4 v112, s[4:7], s80 offen offset:1024 lds
    s_mov_b32 s80, 55296
    buffer_load_dwordx4 v112, s[4:7], s80 offen offset:2048 lds
    s_mov_b32 s80, 82944
    buffer_load_dwordx4 v112, s[4:7], s80 offen offset:3072 lds
    s_add_u32 m0, s79, 12288
    s_mov_b32 s80, 114688
    buffer_load_dwordx4 v112, s[4:7], s80 offen offset:0 lds
    s_mov_b32 s80, 142336
    buffer_load_dwordx4 v112, s[4:7], s80 offen offset:1024 lds
    s_mov_b32 s80, 169984
    buffer_load_dwordx4 v112, s[4:7], s80 offen offset:2048 lds
    s_mov_b32 s80, 197632
    buffer_load_dwordx4 v112, s[4:7], s80 offen offset:3072 lds
    buffer_store_dwordx4 v[88:91], v192, s[32:35], s52 offen sc1
    buffer_store_dwordx4 v[88:91], v192, s[32:35], s53 offen sc1
    s_waitcnt vmcnt(18)
    ds_write_b128 v192, v[202:205] offset:64
    v_mov_b32_dpp v200, v204 wave_shr:1 row_mask:0xf bank_mask:0xf
    v_mov_b32_dpp v201, v205 wave_shr:1 row_mask:0xf bank_mask:0xf
    v_alignbit_b32 v32, v202, v201, 16
    v_alignbit_b32 v33, v203, v202, 16
    v_alignbit_b32 v34, v204, v203, 16
    v_alignbit_b32 v35, v205, v204, 16
    ds_write_b128 v192, v[32:35] offset:4224
    v_mov_b32 v36, v201
    v_mov_b32 v37, v202
    v_mov_b32 v38, v203
    v_mov_b32 v39, v204
    ds_write_b128 v192, v[36:39] offset:8384
    v_alignbit_b32 v40, v201, v200, 16
    v_alignbit_b32 v41, v202, v201, 16
    v_alignbit_b32 v42, v203, v202, 16
    v_alignbit_b32 v43, v204, v203, 16
    ds_write_b128 v192, v[40:43] offset:12544
    s_waitcnt vmcnt(10)
    v_cmp_ne_u32 vcc, s41, v123
    s_cbranch_vccnz L5_rdywait
L5_rdy:
    buffer_store_byte v0, off, s[32:35], s82 offset:2048
L5_rdyskip:
    ds_write_b128 v192, v[210:213] offset:16704
    v_mov_b32_dpp v208, v212 wave_shr:1 row_mask:0xf bank_mask:0xf
    v_mov_b32_dpp v209, v213 wave_shr:1 row_mask:0xf bank_mask:0xf
    v_alignbit_b32 v44, v210, v209, 16
    v_alignbit_b32 v45, v211, v210, 16
    v_alignbit_b32 v46, v212, v211, 16
    v_alignbit_b32 v47, v213, v212, 16
    ds_write_b128 v192, v[44:47] offset:20864
    v_mov_b32 v48, v209
    v_mov_b32 v49, v210
    v_mov_b32 v50, v211
    v_mov_b32 v51, v212
    ds_write_b128 v192, v[48:51] offset:25024
    v_alignbit_b32 v52, v209, v208, 16
    v_alignbit_b32 v53, v210, v209, 16
    v_alignbit_b32 v54, v211, v210, 16
    v_alignbit_b32 v55, v212, v211, 16
    ds_write_b128 v192, v[52:55] offset:29184
    buffer_load_dword v123, v118, s[32:35], s86 offen offset:2048 sc1
    s_lshl_b32 s51, s38, 16
    s_add_u32 s51, s51, 0
    s_add_u32 s50, s51, 32768
    s_mul_i32 s42, s38, 262144
    s_add_u32 s42, s42, 16777216
    s_add_u32 s42, s42, s90
    s_lshl_b32 s43, s39, 13
    s_add_u32 s52, s42, s43
    s_lshr_b32 s75, s39, 1
    s_mul_i32 s75, s75, 65536
    s_add_u32 s42, s42, s75
    s_and_b32 s75, s39, 1
    s_lshl_b32 s75, s75, 12
    s_add_u32 s42, s42, s75
    s_lshl_b32 s75, s38, 16
    s_add_u32 s75, s75, 6291456
    s_lshl_b32 s74, s3, 8
    s_add_u32 s75, s75, s74
    s_add_u32 s81, s75, s43
    s_add_u32 s26, s81, 4096
    s_lshl_b32 s27, s3, 1
    s_lshl_b32 s27, 3, s27
    s_add_u32 s53, s52, 131072
    s_lshl_b32 s74, s39, 10
    s_add_u32 s75, s75, s74
    s_sub_u32 s75, s75, 768
    v_cmp_le_u32 vcc, 768, v8
    v_mov_b32 v120, s42
    v_mov_b32 v121, s75
    v_cndmask_b32 v120, v120, v121, vcc
    v_add_u32 v8, v8, v120
    s_and_b32 s42, s38, 3
    s_lshl_b32 s42, s42, 9
    s_add_u32 s47, s42, s86
    s_lshl_b32 s43, s3, 3
    s_add_u32 s45, s47, s43
    s_add_u32 s44, s45, s39
    s_mov_b32 s68, 0x3f80
    s_mov_b32 s69, 0x3f800000
    s_and_b32 s83, s40, 1
    s_lshl_b32 s83, s83, 4
    s_bfe_u32 s87, s40, 0x20001
    s_add_u32 s83, s83, s87
    s_and_b32 s87, s40, 8
    s_lshl_b32 s87, s87, 2
    s_add_u32 s83, s83, s87
    s_and_b32 s87, s40, 48
    s_lshr_b32 s87, s87, 2
    s_add_u32 s83, s83, s87
    s_and_b32 s87, s40, 192
    s_add_u32 s83, s83, s87
    s_lshl_b32 s83, s83, 6
    s_lshl_b32 s87, s3, 19
    s_add_u32 s83, s83, s87
    s_add_u32 s83, s83, 6291456
    s_add_u32 s87, s83, 262144
    s_lshr_b32 s88, s40, 1
    s_lshl_b32 s88, s88, 14
    s_and_b32 s43, s40, 1
    s_lshl_b32 s43, s43, 5
    s_add_u32 s88, s88, s43
    s_lshl_b32 s43, s3, 12
    s_add_u32 s88, s88, s43
    s_add_u32 s88, s88, 6291456
    s_add_u32 s89, s88, 2048
    s_lshl_b32 s55, s3, 11
    s_add_u32 s54, s51, s55
    s_lshl_b32 s91, s3, 11
    s_add_u32 s91, s91, 47104
    s_sub_u32 s95, 36856, s90
    v_mov_b32 v121, 1
    v_bfe_u32 v200, v31, 4, 1
    v_lshrrev_b32 v205, 5, v31
    v_lshl_add_u32 v200, v205, 3, v200
    v_xor_b32 v200, v200, v198
    v_lshlrev_b32 v200, 4, v200
    v_lshl_add_u32 v200, v199, 8, v200
    v_add_u32 v200, s79, v200
    v_and_b32 v205, 1, v31
    v_bfe_u32 v206, v31, 1, 1
    v_lshl_add_u32 v205, v206, 3, v205
    v_lshrrev_b32 v206, 2, v31
    v_xor_b32 v201, v205, v206
    v_lshlrev_b32 v201, 4, v201
    v_and_b32 v205, 3, v31
    v_lshl_add_u32 v201, v205, 8, v201
    v_add_u32 v201, s91, v201
    v_add_u32 v202, 57344, v201
    v_lshlrev_b32 v204, 3, v31
    v_sub_u32 v204, s95, v204
    v_lshrrev_b32 v203, 2, v31
    v_lshlrev_b32 v203, 14, v203
    v_and_b32 v205, 3, v31
    v_lshl_add_u32 v203, v205, 4, v203
    s_add_u32 m0, s90, 33280
    s_cmp_eq_u32 s48, 2
    s_cbranch_scc1 L5_slow0
    s_waitcnt vmcnt(0)
    v_cmp_ne_u32 vcc, s46, v123
    s_movk_i32 s49, 200
    s_cbranch_vccz L5_got0
L5_spin0:
    buffer_load_dword v123, v118, s[32:35], s86 offen offset:2048 sc1
    s_sub_u32 s49, s49, 1
    s_cbranch_scc1 L5_slow0
    s_waitcnt vmcnt(0)
    v_cmp_ne_u32 vcc, s46, v123
    s_cbranch_vccnz L5_spin0
L5_got0:
    buffer_load_dwordx4 v195, s[32:35], s92 offen sc1 lds
    s_add_u32 m0, s90, 37888
    s_nop 0
    buffer_load_dwordx4 v195, s[32:35], s93 offen sc1 lds
    buffer_store_byte v0, off, s[32:35], s82 offset:2176
    s_cmp_lt_u32 s78, 256
    s_cselect_b32 s24, 128, 0
    s_add_u32 s24, s24, s86
    ds_read_b64_tr_b16 a[0:1], v113 offset:8192
    ds_read_b64_tr_b16 a[2:3], v113 offset:10240
    ds_read_b64_tr_b16 a[4:5], v114 offset:8192
    ds_read_b64_tr_b16 a[6:7], v114 offset:10240
    ds_read_b64_tr_b16 a[8:9], v115 offset:8192
    ds_read_b64_tr_b16 a[10:11], v115 offset:10240
    ds_read_b64_tr_b16 a[12:13], v116 offset:8192
    ds_read_b64_tr_b16 a[14:15], v116 offset:10240
    ds_read_b64_tr_b16 a[16:17], v113 offset:12288
    ds_read_b64_tr_b16 a[18:19], v113 offset:14336
    ds_read_b64_tr_b16 a[20:21], v114 offset:12288
    ds_read_b64_tr_b16 a[22:23], v114 offset:14336
    ds_read_b64_tr_b16 a[24:25], v115 offset:12288
    ds_read_b64_tr_b16 a[26:27], v115 offset:14336
    ds_read_b64_tr_b16 a[28:29], v116 offset:12288
    ds_read_b64_tr_b16 a[30:31], v116 offset:14336
    s_add_u32 m0, s79, 16384
    s_mov_b32 s80, 229376
    buffer_load_dwordx4 v112, s[4:7], s80 offen offset:0 lds
    s_mov_b32 s80, 257024
    buffer_load_dwordx4 v112, s[4:7], s80 offen offset:1024 lds
    s_mov_b32 s80, 284672
    buffer_load_dwordx4 v112, s[4:7], s80 offen offset:2048 lds
    s_mov_b32 s80, 312320
    buffer_load_dwordx4 v112, s[4:7], s80 offen offset:3072 lds
    s_add_u32 m0, s79, 20480
    s_mov_b32 s80, 344064
    buffer_load_dwordx4 v112, s[4:7], s80 offen offset:0 lds
    s_mov_b32 s80, 371712
    buffer_load_dwordx4 v112, s[4:7], s80 offen offset:1024 lds
    s_mov_b32 s80, 399360
    buffer_load_dwordx4 v112, s[4:7], s80 offen offset:2048 lds
    s_mov_b32 s80, 427008
    buffer_load_dwordx4 v112, s[4:7], s80 offen offset:3072 lds
    s_mov_b32 s56, 0x3b000000
    s_mov_b32 s57, 0x3b000000
    s_mov_b32 s58, 0x3c2e990f
    s_mov_b32 s59, 0x3c2e990f
    s_mov_b32 s60, 0x420293ee
    s_mov_b32 s61, 0x420293ee
    s_mov_b32 s62, 0x420293ee
    s_mov_b32 s63, 0x420293ee
    s_mov_b32 s64, 0x3f317218
    s_mov_b32 s65, 0x3f317218
    s_mov_b32 s66, 0x3fb8aa3b
    s_mov_b32 s67, 0x3fb8aa3b
    s_waitcnt vmcnt(9) lgkmcnt(0)
    s_barrier
    s_lshl_b32 s96, s94, 16
    s_and_b32 s98, s94, 0xffff0000
    s_mov_b32 s97, s96
    s_mov_b32 s99, s98
    ds_read_b64 v[64:65], v196 offset:0
    ds_read_b64 v[66:67], v196 offset:8
    ds_read_b128 v[224:227], v197 offset:3584
    ds_read_b64 v[68:69], v196 offset:512
    ds_read_b64 v[70:71], v196 offset:520
    ds_read_b128 v[228:231], v197 offset:3072
    ds_read_b64 v[72:73], v196 offset:1024
    ds_read_b64 v[74:75], v196 offset:1032
    ds_read_b128 v[232:235], v197 offset:2560
    ds_read_b64 v[76:77], v196 offset:1536
    ds_read_b64 v[78:79], v196 offset:1544
    ds_read_b128 v[236:239], v197 offset:2048
    ds_read_b64 v[80:81], v196 offset:2048
    ds_read_b64 v[82:83], v196 offset:2056
    ds_read_b128 v[240:243], v197 offset:1536
    buffer_load_dword v120, v119, s[8:11], s77 offen
    s_add_u32 m0, s79, 24576
    s_mov_b32 s80, 458752
    buffer_load_dwordx4 v112, s[4:7], s80 offen offset:0 lds
    s_mov_b32 s80, 486400
    buffer_load_dwordx4 v112, s[4:7], s80 offen offset:1024 lds
    s_mov_b32 s80, 514048
    buffer_load_dwordx4 v112, s[4:7], s80 offen offset:2048 lds
    s_mov_b32 s80, 541696
    buffer_load_dwordx4 v112, s[4:7], s80 offen offset:3072 lds
    s_waitcnt lgkmcnt(12)
    v_mfma_f32_16x16x32_bf16 v[32:35], v[64:67], v[224:227], 0
    s_waitcnt lgkmcnt(9)
    ds_read_b64 v[84:85], v196 offset:2560
    v_mfma_f32_16x16x32_bf16 v[36:39], v[64:67], v[228:231], 0
    s_add_u32 m0, s79, 8192
    ds_read_b64 v[86:87], v196 offset:2568
    v_mfma_f32_16x16x32_bf16 v[36:39], v[68:71], v[224:227], v[36:39]
    s_mov_b32 s80, 573440
    ds_read_b128 v[244:247], v197 offset:1024
    v_mfma_f32_16x16x32_bf16 v[40:43], v[68:71], v[228:231], 0
    s_waitcnt lgkmcnt(9)
    ds_read_b64 v[88:89], v196 offset:3072
    buffer_load_dwordx4 v112, s[4:7], s80 offen offset:0 lds
    v_mfma_f32_16x16x32_bf16 v[40:43], v[64:67], v[232:235], v[40:43]
    s_mov_b32 s80, 601088
    ds_read_b64 v[90:91], v196 offset:3080
    v_mfma_f32_16x16x32_bf16 v[44:47], v[68:71], v[232:235], 0
    ds_read_b128 v[248:251], v197 offset:512
    v_mfma_f32_16x16x32_bf16 v[40:43], v[72:75], v[224:227], v[40:43]
    ds_read_b64 v[92:93], v196 offset:3584
    v_mfma_f32_16x16x32_bf16 v[44:47], v[72:75], v[228:231], v[44:47]
    ds_read_b64 v[94:95], v196 offset:3592
    v_mfma_f32_16x16x32_bf16 v[48:51], v[72:75], v[232:235], 0
    s_waitcnt lgkmcnt(11)
    ds_read_b128 v[252:255], v197 offset:0
    v_mfma_f32_16x16x32_bf16 v[44:47], v[64:67], v[236:239], v[44:47]
    ds_read_b64 v[128:129], v196 offset:64
    buffer_load_dwordx4 v112, s[4:7], s80 offen offset:1024 lds
    v_mfma_f32_16x16x32_bf16 v[48:51], v[68:71], v[236:239], v[48:51]
    s_mov_b32 s80, 628736
    ds_read_b64 v[130:131], v196 offset:72
    s_waitcnt vmcnt(11)
    ds_read_b64_tr_b16 a[32:33], v113 offset:16384
    v_mfma_f32_16x16x32_bf16 v[52:55], v[72:75], v[236:239], 0
    ds_read_b128 v[160:163], v197 offset:3648
    ds_read_b64_tr_b16 a[34:35], v113 offset:18432
    v_mfma_f32_16x16x32_bf16 v[44:47], v[76:79], v[224:227], v[44:47]
    ds_read_b64 v[132:133], v196 offset:576
    ds_read_b64_tr_b16 a[36:37], v114 offset:16384
    v_mfma_f32_16x16x32_bf16 v[48:51], v[76:79], v[228:231], v[48:51]
    ds_read_b64 v[134:135], v196 offset:584
    ds_read_b64_tr_b16 a[38:39], v114 offset:18432
    v_mfma_f32_16x16x32_bf16 v[52:55], v[76:79], v[232:235], v[52:55]
    ds_read_b128 v[164:167], v197 offset:3136
    ds_read_b64_tr_b16 a[40:41], v115 offset:16384
    v_mfma_f32_16x16x32_bf16 v[56:59], v[76:79], v[236:239], 0
    s_waitcnt lgkmcnt(15)
    ds_read_b64 v[136:137], v196 offset:1088
    buffer_load_dwordx4 v112, s[4:7], s80 offen offset:2048 lds
    v_mfma_f32_16x16x32_bf16 v[48:51], v[64:67], v[240:243], v[48:51]
    s_mov_b32 s80, 656384
    ds_read_b64 v[138:139], v196 offset:1096
    ds_read_b64_tr_b16 a[42:43], v115 offset:18432
    v_mfma_f32_16x16x32_bf16 v[52:55], v[68:71], v[240:243], v[52:55]
    ds_read_b128 v[168:171], v197 offset:2624
    ds_read_b64_tr_b16 a[44:45], v116 offset:16384
    v_mfma_f32_16x16x32_bf16 v[56:59], v[72:75], v[240:243], v[56:59]
    ds_read_b64 v[140:141], v196 offset:1600
    ds_read_b64_tr_b16 a[46:47], v116 offset:18432
    v_mfma_f32_16x16x32_bf16 v[60:63], v[76:79], v[240:243], 0
    ds_read_b64 v[142:143], v196 offset:1608
    v_mfma_f32_16x16x32_bf16 v[48:51], v[80:83], v[224:227], v[48:51]
    ds_read_b128 v[172:175], v197 offset:2112
    buffer_load_dword v123, v118, s[32:35], s24 offen offset:2048 sc1
    v_mfma_f32_16x16x32_bf16 v[52:55], v[80:83], v[228:231], v[52:55]
    ds_read_b64 v[144:145], v196 offset:2112
    buffer_load_dwordx4 v112, s[4:7], s80 offen offset:3072 lds
    v_mfma_f32_16x16x32_bf16 v[56:59], v[80:83], v[232:235], v[56:59]
    s_add_u32 m0, s79, 12288
    ds_read_b64 v[146:147], v196 offset:2120
    v_mfma_f32_16x16x32_bf16 v[60:63], v[80:83], v[236:239], v[60:63]
    s_mov_b32 s80, 688128
    ds_read_b128 v[176:179], v197 offset:1600
    v_mfma_f32_16x16x32_bf16 v[52:55], v[64:67], v[244:247], v[52:55]
    ds_read_b64 v[148:149], v196 offset:2624
    v_mfma_f32_16x16x32_bf16 v[56:59], v[68:71], v[244:247], v[56:59]
    ds_read_b64 v[150:151], v196 offset:2632
    v_mfma_f32_16x16x32_bf16 v[60:63], v[72:75], v[244:247], v[60:63]
    ds_read_b128 v[180:183], v197 offset:1088
    v_mfma_f32_16x16x32_bf16 v[52:55], v[84:87], v[224:227], v[52:55]
    ds_read_b64 v[152:153], v196 offset:3136
    buffer_load_dwordx4 v112, s[4:7], s80 offen offset:0 lds
    v_mfma_f32_16x16x32_bf16 v[56:59], v[84:87], v[228:231], v[56:59]
    s_mov_b32 s80, 715776
    ds_read_b64 v[154:155], v196 offset:3144
    v_mfma_f32_16x16x32_bf16 v[60:63], v[84:87], v[232:235], v[60:63]
    s_waitcnt lgkmcnt(15)
    ds_read_b128 v[184:187], v197 offset:576
    v_mfma_f32_16x16x32_bf16 v[56:59], v[64:67], v[248:251], v[56:59]
    ds_read_b64 v[156:157], v196 offset:3648
    v_mfma_f32_16x16x32_bf16 v[60:63], v[68:71], v[248:251], v[60:63]
    ds_read_b64 v[158:159], v196 offset:3656
    v_mfma_f32_16x16x32_bf16 v[56:59], v[88:91], v[224:227], v[56:59]
    ds_read_b128 v[188:191], v197 offset:64
    v_mfma_f32_16x16x32_bf16 v[60:63], v[88:91], v[228:231], v[60:63]
    buffer_load_dwordx4 v112, s[4:7], s80 offen offset:1024 lds
    v_mfma_f32_16x16x32_bf16 v[60:63], v[64:67], v[252:255], v[60:63]
    s_mov_b32 s80, 743424
    s_waitcnt vmcnt(12)
    ds_read_b64_tr_b16 a[48:49], v113 offset:20480
    v_mfma_f32_16x16x32_bf16 v[60:63], v[92:95], v[224:227], v[60:63]
    s_waitcnt lgkmcnt(1)
    ds_read_b64_tr_b16 a[50:51], v113 offset:22528
    v_mfma_f32_16x16x32_bf16 v[60:63], v[128:131], v[188:191], v[60:63]
    ds_read_b64_tr_b16 a[52:53], v114 offset:20480
    v_mfma_f32_16x16x32_bf16 v[60:63], v[132:135], v[184:187], v[60:63]
    ds_read_b64_tr_b16 a[54:55], v114 offset:22528
    v_mfma_f32_16x16x32_bf16 v[60:63], v[136:139], v[180:183], v[60:63]
    ds_read_b64_tr_b16 a[56:57], v115 offset:20480
    v_mfma_f32_16x16x32_bf16 v[60:63], v[140:143], v[176:179], v[60:63]
    buffer_load_dwordx4 v112, s[4:7], s80 offen offset:2048 lds
    v_mfma_f32_16x16x32_bf16 v[60:63], v[144:147], v[172:175], v[60:63]
    s_mov_b32 s80, 771072
    ds_read_b64_tr_b16 a[58:59], v115 offset:22528
    v_mfma_f32_16x16x32_bf16 v[60:63], v[148:151], v[168:171], v[60:63]
    ds_read_b64_tr_b16 a[60:61], v116 offset:20480
    v_mfma_f32_16x16x32_bf16 v[60:63], v[152:155], v[164:167], v[60:63]
    ds_read_b64_tr_b16 a[62:63], v116 offset:22528
    v_mfma_f32_16x16x32_bf16 v[60:63], v[156:159], v[160:163], v[60:63]
    ds_read_b64 v[64:65], v196 offset:128
    v_mfma_f32_16x16x32_bf16 v[56:59], v[128:131], v[184:187], v[56:59]
    ds_read_b64 v[66:67], v196 offset:136
    v_mfma_f32_16x16x32_bf16 v[56:59], v[132:135], v[180:183], v[56:59]
    buffer_load_dwordx4 v112, s[4:7], s80 offen offset:3072 lds
    v_mfma_f32_16x16x32_bf16 v[56:59], v[136:139], v[176:179], v[56:59]
    s_add_u32 m0, s79, 16384
    ds_read_b128 v[224:227], v197 offset:3712
    v_mfma_f32_16x16x32_bf16 v[56:59], v[140:143], v[172:175], v[56:59]
    s_mov_b32 s80, 802816
    ds_read_b64 v[68:69], v196 offset:640
    v_mfma_f32_16x16x32_bf16 v[56:59], v[144:147], v[168:171], v[56:59]
    ds_read_b64 v[70:71], v196 offset:648
    v_mfma_f32_16x16x32_bf16 v[56:59], v[148:151], v[164:167], v[56:59]
    ds_read_b128 v[228:231], v197 offset:3200
    v_mfma_f32_16x16x32_bf16 v[56:59], v[152:155], v[160:163], v[56:59]
    ds_read_b64 v[72:73], v196 offset:1152
    v_mfma_f32_16x16x32_bf16 v[52:55], v[128:131], v[180:183], v[52:55]
    buffer_load_dwordx4 v112, s[4:7], s80 offen offset:0 lds
    v_mfma_f32_16x16x32_bf16 v[52:55], v[132:135], v[176:179], v[52:55]
    s_mov_b32 s80, 830464
    ds_read_b64 v[74:75], v196 offset:1160
    v_mfma_f32_16x16x32_bf16 v[52:55], v[136:139], v[172:175], v[52:55]
    ds_read_b128 v[232:235], v197 offset:2688
    v_mfma_f32_16x16x32_bf16 v[52:55], v[140:143], v[168:171], v[52:55]
    ds_read_b64 v[76:77], v196 offset:1664
    v_mfma_f32_16x16x32_bf16 v[52:55], v[144:147], v[164:167], v[52:55]
    ds_read_b64 v[78:79], v196 offset:1672
    v_mfma_f32_16x16x32_bf16 v[52:55], v[148:151], v[160:163], v[52:55]
    ds_read_b128 v[236:239], v197 offset:2176
    v_mfma_f32_16x16x32_bf16 v[48:51], v[128:131], v[176:179], v[48:51]
    ds_read_b64 v[80:81], v196 offset:2176
    buffer_load_dwordx4 v112, s[4:7], s80 offen offset:1024 lds
    v_mfma_f32_16x16x32_bf16 v[48:51], v[132:135], v[172:175], v[48:51]
    s_mov_b32 s80, 858112
    ds_read_b64 v[82:83], v196 offset:2184
    s_waitcnt vmcnt(11)
    ds_read_b64_tr_b16 a[64:65], v113 offset:24576
    v_mfma_f32_16x16x32_bf16 v[48:51], v[136:139], v[168:171], v[48:51]
    ds_read_b128 v[240:243], v197 offset:1664
    ds_read_b64_tr_b16 a[66:67], v113 offset:26624
    v_mfma_f32_16x16x32_bf16 v[48:51], v[140:143], v[164:167], v[48:51]
    ds_read_b64 v[84:85], v196 offset:2688
    ds_read_b64_tr_b16 a[68:69], v114 offset:24576
    v_mfma_f32_16x16x32_bf16 v[48:51], v[144:147], v[160:163], v[48:51]
    ds_read_b64 v[86:87], v196 offset:2696
    ds_read_b64_tr_b16 a[70:71], v114 offset:26624
    v_mfma_f32_16x16x32_bf16 v[44:47], v[128:131], v[172:175], v[44:47]
    ds_read_b128 v[244:247], v197 offset:1152
    ds_read_b64_tr_b16 a[72:73], v115 offset:24576
    v_mfma_f32_16x16x32_bf16 v[44:47], v[132:135], v[168:171], v[44:47]
    ds_read_b64 v[88:89], v196 offset:3200
    buffer_load_dwordx4 v112, s[4:7], s80 offen offset:2048 lds
    v_mfma_f32_16x16x32_bf16 v[44:47], v[136:139], v[164:167], v[44:47]
    s_mov_b32 s80, 885760
    ds_read_b64 v[90:91], v196 offset:3208
    ds_read_b64_tr_b16 a[74:75], v115 offset:26624
    v_mfma_f32_16x16x32_bf16 v[44:47], v[140:143], v[160:163], v[44:47]
    ds_read_b128 v[248:251], v197 offset:640
    ds_read_b64_tr_b16 a[76:77], v116 offset:24576
    v_mfma_f32_16x16x32_bf16 v[40:43], v[128:131], v[168:171], v[40:43]
    ds_read_b64 v[92:93], v196 offset:3712
    ds_read_b64_tr_b16 a[78:79], v116 offset:26624
    v_mfma_f32_16x16x32_bf16 v[40:43], v[132:135], v[164:167], v[40:43]
    ds_read_b64 v[94:95], v196 offset:3720
    v_mfma_f32_16x16x32_bf16 v[40:43], v[136:139], v[160:163], v[40:43]
    ds_read_b128 v[252:255], v197 offset:128
    v_mfma_f32_16x16x32_bf16 v[36:39], v[128:131], v[164:167], v[36:39]
    buffer_load_dwordx4 v112, s[4:7], s80 offen offset:3072 lds
    v_mfma_f32_16x16x32_bf16 v[36:39], v[132:135], v[160:163], v[36:39]
    s_add_u32 m0, s79, 20480
    s_waitcnt vmcnt(9)
    v_cmp_ne_u32 vcc, s46, v123
    v_mfma_f32_16x16x32_bf16 v[32:35], v[128:131], v[160:163], v[32:35]
    s_waitcnt lgkmcnt(0)
    v_mfma_f32_16x16x32_bf16 v[60:63], v[64:67], v[252:255], v[60:63]
    s_mov_b32 s80, 917504
    s_cbranch_vccnz L5_wait2
L5_got2:
    buffer_store_dword v121, off, s[28:31], s78 offset:128 sc1
    v_mfma_f32_16x16x32_bf16 v[60:63], v[68:71], v[248:251], v[60:63]
    ds_read_b64 v[128:129], v196 offset:192
    v_mfma_f32_16x16x32_bf16 v[60:63], v[72:75], v[244:247], v[60:63]
    ds_read_b64 v[130:131], v196 offset:200
    v_mfma_f32_16x16x32_bf16 v[60:63], v[76:79], v[240:243], v[60:63]
    buffer_load_dwordx4 v112, s[4:7], s80 offen offset:0 lds
    v_mfma_f32_16x16x32_bf16 v[60:63], v[80:83], v[236:239], v[60:63]
    s_mov_b32 s80, 945152
    ds_read_b128 v[160:163], v197 offset:3776
    v_mfma_f32_16x16x32_bf16 v[60:63], v[84:87], v[232:235], v[60:63]
    ds_read_b64 v[132:133], v196 offset:704
    v_mfma_f32_16x16x32_bf16 v[60:63], v[88:91], v[228:231], v[60:63]
    ds_read_b64 v[134:135], v196 offset:712
    v_mfma_f32_16x16x32_bf16 v[60:63], v[92:95], v[224:227], v[60:63]
    ds_read_b128 v[164:167], v197 offset:3264
    v_mfma_f32_16x16x32_bf16 v[56:59], v[64:67], v[248:251], v[56:59]
    ds_read_b64 v[136:137], v196 offset:1216
    v_mfma_f32_16x16x32_bf16 v[56:59], v[68:71], v[244:247], v[56:59]
    buffer_load_dwordx4 v112, s[4:7], s80 offen offset:1024 lds
    v_mfma_f32_16x16x32_bf16 v[56:59], v[72:75], v[240:243], v[56:59]
    s_mov_b32 s80, 972800
    s_waitcnt vmcnt(11)
    ds_read_b64_tr_b16 a[80:81], v113 offset:8192
    v_mfma_f32_16x16x32_bf16 v[56:59], v[76:79], v[236:239], v[56:59]
    ds_read_b64_tr_b16 a[82:83], v113 offset:10240
    v_mfma_f32_16x16x32_bf16 v[56:59], v[80:83], v[232:235], v[56:59]
    ds_read_b64_tr_b16 a[84:85], v114 offset:8192
    v_mfma_f32_16x16x32_bf16 v[56:59], v[84:87], v[228:231], v[56:59]
    ds_read_b64_tr_b16 a[86:87], v114 offset:10240
    v_mfma_f32_16x16x32_bf16 v[56:59], v[88:91], v[224:227], v[56:59]
    ds_read_b64_tr_b16 a[88:89], v115 offset:8192
LP_0:
    s_cbranch_execz LP_1
    v_mfma_f32_16x16x32_bf16 v[52:55], v[64:67], v[244:247], v[52:55]
    buffer_load_dwordx4 v112, s[4:7], s80 offen offset:2048 lds
    v_mfma_f32_16x16x32_bf16 v[52:55], v[68:71], v[240:243], v[52:55]
    s_mov_b32 s80, 1000448
    ds_read_b64 v[138:139], v196 offset:1224
    ds_read_b64_tr_b16 a[90:91], v115 offset:10240
    v_mfma_f32_16x16x32_bf16 v[52:55], v[72:75], v[236:239], v[52:55]
    ds_read_b128 v[168:171], v197 offset:2752
    ds_read_b64_tr_b16 a[92:93], v116 offset:8192
    v_mfma_f32_16x16x32_bf16 v[52:55], v[76:79], v[232:235], v[52:55]
    ds_read_b64 v[140:141], v196 offset:1728
    buffer_load_dwordx4 v[22:25], v10, s[16:19], 0 offen offset:0
    v_mfma_f32_16x16x32_bf16 v[52:55], v[80:83], v[228:231], v[52:55]
    ds_read_b64 v[142:143], v196 offset:1736
    ds_read_b64_tr_b16 a[94:95], v116 offset:10240
    v_mfma_f32_16x16x32_bf16 v[52:55], v[84:87], v[224:227], v[52:55]
    ds_read_b128 v[172:175], v197 offset:2240
    v_mfma_f32_16x16x32_bf16 v[48:51], v[64:67], v[240:243], v[48:51]
    ds_read_b64 v[144:145], v196 offset:2240
    buffer_load_dwordx4 v112, s[4:7], s80 offen offset:3072 lds
    v_mfma_f32_16x16x32_bf16 v[48:51], v[68:71], v[236:239], v[48:51]
    s_add_u32 m0, s79, 24576
    ds_read_b64 v[146:147], v196 offset:2248
    buffer_load_dwordx4 v[26:29], v10, s[16:19], 0 offen offset:1024
    v_mfma_f32_16x16x32_bf16 v[48:51], v[72:75], v[232:235], v[48:51]
    s_mov_b32 s80, 1032192
    ds_read_b128 v[176:179], v197 offset:1728
    v_mfma_f32_16x16x32_bf16 v[48:51], v[76:79], v[228:231], v[48:51]
    ds_read_b64 v[148:149], v196 offset:2752
    v_mfma_f32_16x16x32_bf16 v[48:51], v[80:83], v[224:227], v[48:51]
    ds_read_b64 v[150:151], v196 offset:2760
    v_mfma_f32_16x16x32_bf16 v[44:47], v[64:67], v[236:239], v[44:47]
    ds_read_b128 v[180:183], v197 offset:1216
    v_mfma_f32_16x16x32_bf16 v[44:47], v[68:71], v[232:235], v[44:47]
    ds_read_b64 v[152:153], v196 offset:3264
    buffer_load_dwordx4 v112, s[4:7], s80 offen offset:0 lds
    v_mfma_f32_16x16x32_bf16 v[44:47], v[72:75], v[228:231], v[44:47]
    s_mov_b32 s80, 1059840
    ds_read_b64 v[154:155], v196 offset:3272
    v_mfma_f32_16x16x32_bf16 v[44:47], v[76:79], v[224:227], v[44:47]
    ds_read_b128 v[184:187], v197 offset:704
    v_mfma_f32_16x16x32_bf16 v[40:43], v[64:67], v[232:235], v[40:43]
    ds_read_b64 v[156:157], v196 offset:3776
    v_mfma_f32_16x16x32_bf16 v[40:43], v[68:71], v[228:231], v[40:43]
    ds_read_b64 v[158:159], v196 offset:3784
    v_mfma_f32_16x16x32_bf16 v[40:43], v[72:75], v[224:227], v[40:43]
    ds_read_b128 v[188:191], v197 offset:192
    v_mfma_f32_16x16x32_bf16 v[36:39], v[64:67], v[228:231], v[36:39]
    buffer_load_dwordx4 v112, s[4:7], s80 offen offset:1024 lds
    v_mfma_f32_16x16x32_bf16 v[36:39], v[68:71], v[224:227], v[36:39]
    s_mov_b32 s80, 1087488
    s_waitcnt vmcnt(13)
    ds_read_b64_tr_b16 a[96:97], v113 offset:12288
    v_mfma_f32_16x16x32_bf16 v[32:35], v[64:67], v[224:227], v[32:35]
    s_waitcnt lgkmcnt(1)
    ds_read_b64_tr_b16 a[98:99], v113 offset:14336
    v_mfma_f32_16x16x32_bf16 v[60:63], v[128:131], v[188:191], v[60:63]
    ds_read_b64_tr_b16 a[100:101], v114 offset:12288
    v_mfma_f32_16x16x32_bf16 v[60:63], v[132:135], v[184:187], v[60:63]
    ds_read_b64_tr_b16 a[102:103], v114 offset:14336
    v_mfma_f32_16x16x32_bf16 v[60:63], v[136:139], v[180:183], v[60:63]
    ds_read_b64_tr_b16 a[104:105], v115 offset:12288
    v_mfma_f32_16x16x32_bf16 v[60:63], v[140:143], v[176:179], v[60:63]
    buffer_load_dwordx4 v112, s[4:7], s80 offen offset:2048 lds
    v_mfma_f32_16x16x32_bf16 v[60:63], v[144:147], v[172:175], v[60:63]
    s_mov_b32 s80, 1115136
    ds_read_b64_tr_b16 a[106:107], v115 offset:14336
    v_mfma_f32_16x16x32_bf16 v[60:63], v[148:151], v[168:171], v[60:63]
    ds_read_b64_tr_b16 a[108:109], v116 offset:12288
    v_mfma_f32_16x16x32_bf16 v[60:63], v[152:155], v[164:167], v[60:63]
    ds_read_b64_tr_b16 a[110:111], v116 offset:14336
    v_mfma_f32_16x16x32_bf16 v[60:63], v[156:159], v[160:163], v[60:63]
    v_mfma_f32_16x16x32_bf16 v[56:59], v[128:131], v[184:187], v[56:59]
    v_mfma_f32_16x16x32_bf16 v[56:59], v[132:135], v[180:183], v[56:59]
    buffer_load_dwordx4 v112, s[4:7], s80 offen offset:3072 lds
    v_mfma_f32_16x16x32_bf16 v[56:59], v[136:139], v[176:179], v[56:59]
    s_add_u32 m0, s79, 8192
    v_mfma_f32_16x16x32_bf16 v[56:59], v[140:143], v[172:175], v[56:59]
    s_mov_b32 s80, 1146880
    v_mfma_f32_16x16x32_bf16 v[56:59], v[144:147], v[168:171], v[56:59]
    ds_write_b128 v200, v[60:63] offset:7168
    v_mfma_f32_16x16x32_bf16 v[56:59], v[148:151], v[164:167], v[56:59]
    v_mfma_f32_16x16x32_bf16 v[56:59], v[152:155], v[160:163], v[56:59]
    v_mfma_f32_16x16x32_bf16 v[52:55], v[128:131], v[180:183], v[52:55]
    buffer_load_dwordx4 v112, s[4:7], s80 offen offset:0 lds
    v_mfma_f32_16x16x32_bf16 v[52:55], v[132:135], v[176:179], v[52:55]
    s_mov_b32 s80, 1174528
    v_mfma_f32_16x16x32_bf16 v[52:55], v[136:139], v[172:175], v[52:55]
    v_mfma_f32_16x16x32_bf16 v[52:55], v[140:143], v[168:171], v[52:55]
    v_lshrrev_b32 v119, 1, v1
    buffer_load_dword v123, v119, s[32:35], s47 offen sc1
    v_mfma_f32_16x16x32_bf16 v[52:55], v[144:147], v[164:167], v[52:55]
    ds_write_b128 v200, v[56:59] offset:6144
    v_mfma_f32_16x16x32_bf16 v[52:55], v[148:151], v[160:163], v[52:55]
    ds_read_b64 v[210:211], v204 offset:512
    ds_read_b64 v[212:213], v204 offset:5120
    ds_read_b64 v[214:215], v204 offset:0
    ds_read_b64 v[216:217], v204 offset:4608
    v_mfma_f32_16x16x32_bf16 v[48:51], v[128:131], v[176:179], v[48:51]
    buffer_load_dwordx4 v112, s[4:7], s80 offen offset:1024 lds
    v_mfma_f32_16x16x32_bf16 v[48:51], v[132:135], v[172:175], v[48:51]
    s_mov_b32 s80, 1202176
    buffer_load_dword v123, v3, s[28:31], 0 offen offset:128 sc1
    v_mfma_f32_16x16x32_bf16 v[48:51], v[136:139], v[168:171], v[48:51]
    s_waitcnt vmcnt(15)
    ds_read_b64_tr_b16 a[112:113], v113 offset:16384
    v_mfma_f32_16x16x32_bf16 v[48:51], v[140:143], v[164:167], v[48:51]
    ds_read_b64_tr_b16 a[114:115], v113 offset:18432
    v_mfma_f32_16x16x32_bf16 v[48:51], v[144:147], v[160:163], v[48:51]
    ds_write_b128 v200, v[52:55] offset:5120
    v_mfma_f32_16x16x32_bf16 v[44:47], v[128:131], v[172:175], v[44:47]
    ds_read_b64_tr_b16 a[116:117], v114 offset:16384
    v_mfma_f32_16x16x32_bf16 v[44:47], v[132:135], v[168:171], v[44:47]
    buffer_load_dwordx4 v112, s[4:7], s80 offen offset:2048 lds
    v_mfma_f32_16x16x32_bf16 v[44:47], v[136:139], v[164:167], v[44:47]
    s_mov_b32 s80, 1229824
    ds_read_b64_tr_b16 a[118:119], v114 offset:18432
    v_mfma_f32_16x16x32_bf16 v[44:47], v[140:143], v[160:163], v[44:47]
    ds_read_b64_tr_b16 a[120:121], v115 offset:16384
    v_mfma_f32_16x16x32_bf16 v[40:43], v[128:131], v[168:171], v[40:43]
    ds_write_b128 v200, v[48:51] offset:4096
    v_mfma_f32_16x16x32_bf16 v[40:43], v[132:135], v[164:167], v[40:43]
    ds_read_b64_tr_b16 a[122:123], v115 offset:18432
    v_mfma_f32_16x16x32_bf16 v[40:43], v[136:139], v[160:163], v[40:43]
    ds_read_b64_tr_b16 a[124:125], v116 offset:16384
    v_mfma_f32_16x16x32_bf16 v[36:39], v[128:131], v[164:167], v[36:39]
    buffer_load_dwordx4 v112, s[4:7], s80 offen offset:3072 lds
    v_mfma_f32_16x16x32_bf16 v[36:39], v[132:135], v[160:163], v[36:39]
    s_add_u32 m0, s79, 12288
    ds_write_b128 v200, v[44:47] offset:3072
    v_mfma_f32_16x16x32_bf16 v[32:35], v[128:131], v[160:163], v[32:35]
    s_mov_b32 s80, 1261568
    ds_read_b64_tr_b16 a[126:127], v116 offset:18432
    s_waitcnt lgkmcnt(11)
    v_and_b32 v96, s70, v211
    v_lshlrev_b32 v97, 16, v211
    v_and_b32 v98, s70, v210
    v_lshlrev_b32 v99, 16, v210
    v_and_b32 v100, s70, v213
    v_lshlrev_b32 v101, 16, v213
    v_and_b32 v102, s70, v212
    v_lshlrev_b32 v103, 16, v212
    ds_write_b128 v200, v[40:43] offset:2048
    ds_write_b128 v200, v[36:39] offset:1024
    ds_write_b128 v200, v[32:35] offset:0
    buffer_load_dwordx4 v112, s[4:7], s80 offen offset:0 lds
    s_mov_b32 s80, 1289216
    buffer_load_dwordx4 v112, s[4:7], s80 offen offset:1024 lds
    s_mov_b32 s80, 1316864
    buffer_load_dwordx4 v112, s[4:7], s80 offen offset:2048 lds
    s_waitcnt lgkmcnt(0)
    s_barrier
    ds_read_b128 v[64:67], v201 offset:0
    ds_read_b128 v[68:71], v201 offset:28672
    ds_read_b128 v[72:75], v202 offset:0
    ds_read_b128 v[76:79], v202 offset:28672
    v_and_b32 v104, s70, v215
    v_lshlrev_b32 v105, 16, v215
    v_and_b32 v106, s70, v214
    v_lshlrev_b32 v107, 16, v214
    v_and_b32 v108, s70, v217
    v_lshlrev_b32 v109, 16, v217
    v_and_b32 v110, s70, v216
    v_lshlrev_b32 v111, 16, v216
    ds_read_b128 v[80:83], v201 offset:1024
    ds_read_b128 v[84:87], v201 offset:29696
    ds_read_b128 v[88:91], v202 offset:1024
    ds_read_b128 v[92:95], v202 offset:29696
    s_mov_b32 s80, 1344512
    buffer_load_dwordx4 v112, s[4:7], s80 offen offset:3072 lds
    s_waitcnt vmcnt(15)
    ds_read_b64_tr_b16 a[128:129], v113 offset:20480
    ds_read_b64_tr_b16 a[130:131], v113 offset:22528
    s_add_u32 m0, s79, 16384
    s_mov_b32 s80, 1376256
    buffer_load_dwordx4 v112, s[4:7], s80 offen offset:0 lds
    ds_read_b64_tr_b16 a[132:133], v114 offset:20480
    ds_read_b64_tr_b16 a[134:135], v114 offset:22528
    s_waitcnt lgkmcnt(8)
    v_pk_fma_f32 v[64:65], v[96:97], s[96:97], v[64:65]
    v_pk_fma_f32 v[66:67], v[98:99], s[96:97], v[66:67]
    v_pk_add_f32 v[64:65], v[64:65], v[68:69]
    v_pk_add_f32 v[66:67], v[66:67], v[70:71]
    v_pk_fma_f32 v[72:73], v[100:101], s[98:99], v[72:73]
    v_pk_fma_f32 v[74:75], v[102:103], s[98:99], v[74:75]
    v_pk_add_f32 v[72:73], v[72:73], v[76:77]
    v_pk_add_f32 v[74:75], v[74:75], v[78:79]
    v_cvt_pk_bf16_f32 v68, v64, v72
    v_cvt_pk_bf16_f32 v69, v65, v73
    v_cvt_pk_bf16_f32 v70, v66, v74
    v_cvt_pk_bf16_f32 v71, v67, v75
    s_waitcnt lgkmcnt(4)
    v_pk_fma_f32 v[80:81], v[104:105], s[96:97], v[80:81]
    v_pk_fma_f32 v[82:83], v[106:107], s[96:97], v[82:83]
    v_pk_add_f32 v[80:81], v[80:81], v[84:85]
    v_pk_add_f32 v[82:83], v[82:83], v[86:87]
    v_pk_fma_f32 v[88:89], v[108:109], s[98:99], v[88:89]
    v_pk_fma_f32 v[90:91], v[110:111], s[98:99], v[90:91]
    v_pk_add_f32 v[88:89], v[88:89], v[92:93]
    v_pk_add_f32 v[90:91], v[90:91], v[94:95]
    v_cvt_pk_bf16_f32 v84, v80, v88
    v_cvt_pk_bf16_f32 v85, v81, v89
    v_cvt_pk_bf16_f32 v86, v82, v90
    v_cvt_pk_bf16_f32 v87, v83, v91
    s_waitcnt vmcnt(7)
    v_cmp_ne_u32 vcc, 1, v123
    s_cbranch_vccnz L5_rwait
L5_rgot:
    buffer_store_dwordx4 v[68:71], v203, s[32:35], s83 offen sc1
    buffer_store_dwordx4 v[84:87], v203, s[32:35], s87 offen sc1
    s_mov_b32 vcc_lo, 0xaaaaaaaa
    s_mov_b32 vcc_hi, 0xaaaaaaaa
    v_cndmask_b32_dpp v16, v22, v24, vcc quad_perm:[1,0,3,2] row_mask:0xf bank_mask:0xf
    v_cndmask_b32_dpp v17, v23, v25, vcc quad_perm:[1,0,3,2] row_mask:0xf bank_mask:0xf
    v_cndmask_b32_dpp v20, v26, v28, vcc quad_perm:[1,0,3,2] row_mask:0xf bank_mask:0xf
    v_cndmask_b32_dpp v21, v27, v29, vcc quad_perm:[1,0,3,2] row_mask:0xf bank_mask:0xf
    s_not_b64 vcc, vcc
    v_cndmask_b32_dpp v14, v24, v22, vcc quad_perm:[1,0,3,2] row_mask:0xf bank_mask:0xf
    v_cndmask_b32_dpp v15, v25, v23, vcc quad_perm:[1,0,3,2] row_mask:0xf bank_mask:0xf
    v_cndmask_b32_dpp v18, v28, v26, vcc quad_perm:[1,0,3,2] row_mask:0xf bank_mask:0xf
    v_cndmask_b32_dpp v19, v29, v27, vcc quad_perm:[1,0,3,2] row_mask:0xf bank_mask:0xf
    v_lshlrev_b32 v30, 16, v14
    v_and_b32 v31, s70, v14
    v_lshlrev_b32 v32, 16, v15
    v_and_b32 v33, s70, v15
    v_lshlrev_b32 v34, 16, v16
    v_and_b32 v35, s70, v16
    v_lshlrev_b32 v36, 16, v17
    v_and_b32 v37, s70, v17
    s_mov_b32 s80, 1403904
    buffer_load_dwordx4 v112, s[4:7], s80 offen offset:1024 lds
    ds_read_b64_tr_b16 a[136:137], v115 offset:20480
    ds_read_b64_tr_b16 a[138:139], v115 offset:22528
    v_lshlrev_b32 v38, 16, v18
    v_and_b32 v39, s70, v18
    v_lshlrev_b32 v40, 16, v19
    v_and_b32 v41, s70, v19
    v_lshlrev_b32 v42, 16, v20
    v_and_b32 v43, s70, v20
    v_lshlrev_b32 v44, 16, v21
    v_and_b32 v45, s70, v21
    s_mov_b32 s80, 1431552
    buffer_load_dwordx4 v112, s[4:7], s80 offen offset:2048 lds
    ds_read_b64_tr_b16 a[140:141], v116 offset:20480
    ds_read_b64_tr_b16 a[142:143], v116 offset:22528
    v_pk_mul_f32 v[30:31], v[30:31], s[66:67]
    v_pk_mul_f32 v[32:33], v[32:33], s[66:67]
    v_pk_mul_f32 v[34:35], v[34:35], s[66:67]
    v_pk_mul_f32 v[36:37], v[36:37], s[66:67]
    v_pk_mul_f32 v[38:39], v[38:39], s[66:67]
    v_pk_mul_f32 v[40:41], v[40:41], s[66:67]
    v_pk_mul_f32 v[42:43], v[42:43], s[66:67]
    v_pk_mul_f32 v[44:45], v[44:45], s[66:67]
    v_pk_add_f32 v[62:63], v[30:31], v[32:33]
    v_pk_add_f32 v[64:65], v[38:39], v[40:41]
    v_pk_mul_f32 v[66:67], v[30:31], v[30:31]
    v_pk_mul_f32 v[68:69], v[38:39], v[38:39]
    v_pk_add_f32 v[62:63], v[62:63], v[34:35]
    v_pk_add_f32 v[64:65], v[64:65], v[42:43]
    v_pk_add_f32 v[62:63], v[62:63], v[36:37]
    v_pk_add_f32 v[64:65], v[64:65], v[44:45]
    v_pk_fma_f32 v[66:67], v[32:33], v[32:33], v[66:67]
    v_pk_fma_f32 v[68:69], v[40:41], v[40:41], v[68:69]
    v_pk_fma_f32 v[66:67], v[34:35], v[34:35], v[66:67]
    v_pk_fma_f32 v[68:69], v[42:43], v[42:43], v[68:69]
    v_pk_fma_f32 v[66:67], v[36:37], v[36:37], v[66:67]
    v_pk_fma_f32 v[68:69], v[44:45], v[44:45], v[68:69]
    v_add_f32 v62, v62, v63
    v_add_f32 v64, v64, v65
    v_add_f32 v66, v66, v67
    v_add_f32 v68, v68, v69
    v_permlane16_swap_b32 v62, v64
    s_nop 0
    v_permlane16_swap_b32 v66, v68
    v_add_f32 v62, v62, v64
    v_add_f32 v66, v66, v68
    s_nop 0
    v_add_f32_dpp v62, v62, v62 quad_perm:[1,0,3,2] row_mask:0xf bank_mask:0xf
    v_add_f32_dpp v66, v66, v66 quad_perm:[1,0,3,2] row_mask:0xf bank_mask:0xf
    s_nop 0
    v_add_f32_dpp v62, v62, v62 row_ror:4 row_mask:0xf bank_mask:0xf
    v_add_f32_dpp v66, v66, v66 row_ror:4 row_mask:0xf bank_mask:0xf
    s_nop 0
    v_add_f32_dpp v62, v62, v62 row_ror:8 row_mask:0xf bank_mask:0xf
    v_add_f32_dpp v66, v66, v66 row_ror:8 row_mask:0xf bank_mask:0xf
    ds_write2_b32 v11, v62, v66 offset0:0 offset1:2
    s_mov_b32 s80, 1459200
    buffer_load_dwordx4 v112, s[4:7], s80 offen offset:3072 lds
    ds_read_b64_tr_b16 a[144:145], v113 offset:24576
    ds_read_b64_tr_b16 a[146:147], v113 offset:26624
    s_add_u32 m0, s79, 20480
    s_mov_b32 s80, 1490944
    s_waitcnt lgkmcnt(3)
    buffer_load_dwordx4 v112, s[4:7], s80 offen offset:0 lds
    ds_read_b64_tr_b16 a[148:149], v114 offset:24576
    ds_read_b64_tr_b16 a[150:151], v114 offset:26624
    s_waitcnt lgkmcnt(0)
    s_barrier
    ds_read_b128 v[72:75], v12 offset:0
    ds_read_b128 v[76:79], v12 offset:16
    ds_read_b128 v[80:83], v12 offset:32
    ds_read_b128 v[84:87], v12 offset:48
    s_mov_b32 s80, 1518592
    buffer_load_dwordx4 v112, s[4:7], s80 offen offset:1024 lds
    ds_read_b64_tr_b16 a[152:153], v115 offset:24576
    ds_read_b64_tr_b16 a[154:155], v115 offset:26624
    s_mov_b32 s80, 1546240
    buffer_load_dwordx4 v112, s[4:7], s80 offen offset:2048 lds
    ds_read_b64_tr_b16 a[156:157], v116 offset:24576
    ds_read_b64_tr_b16 a[158:159], v116 offset:26624
    s_waitcnt lgkmcnt(6)
    v_pk_add_f32 v[72:73], v[72:73], v[76:77]
    v_pk_add_f32 v[74:75], v[74:75], v[78:79]
    s_waitcnt lgkmcnt(4)
    v_pk_add_f32 v[80:81], v[80:81], v[84:85]
    v_pk_add_f32 v[82:83], v[82:83], v[86:87]
    v_pk_add_f32 v[72:73], v[72:73], v[80:81]
    v_pk_add_f32 v[74:75], v[74:75], v[82:83]
    v_pk_mul_f32 v[90:91], v[72:73], s[56:57]
    v_pk_add_f32 v[74:75], v[74:75], s[58:59]
    v_pk_fma_f32 v[74:75], v[72:73], v[90:91], v[74:75] neg_lo:[1,0,0] neg_hi:[1,0,0]
    v_max_f32 v74, s58, v74
    v_max_f32 v75, s58, v75
    v_rsq_f32 v92, v74
    v_rsq_f32 v93, v75
    s_nop 0
    v_pk_mul_f32 v[92:93], v[92:93], s[60:61]
    v_pk_mul_f32 v[94:95], v[90:91], v[92:93] neg_lo:[1,0] neg_hi:[1,0]
    v_pk_fma_f32 v[96:97], v[30:31], v[92:93], v[94:95] op_sel:[0,0,0] op_sel_hi:[1,0,0]
    v_pk_fma_f32 v[98:99], v[32:33], v[92:93], v[94:95] op_sel:[0,0,0] op_sel_hi:[1,0,0]
    v_pk_fma_f32 v[100:101], v[34:35], v[92:93], v[94:95] op_sel:[0,0,0] op_sel_hi:[1,0,0]
    v_pk_fma_f32 v[102:103], v[36:37], v[92:93], v[94:95] op_sel:[0,0,0] op_sel_hi:[1,0,0]
    v_pk_fma_f32 v[104:105], v[38:39], v[92:93], v[94:95] op_sel:[0,1,1] op_sel_hi:[1,1,1]
    v_pk_fma_f32 v[106:107], v[40:41], v[92:93], v[94:95] op_sel:[0,1,1] op_sel_hi:[1,1,1]
    v_pk_fma_f32 v[108:109], v[42:43], v[92:93], v[94:95] op_sel:[0,1,1] op_sel_hi:[1,1,1]
    v_pk_fma_f32 v[110:111], v[44:45], v[92:93], v[94:95] op_sel:[0,1,1] op_sel_hi:[1,1,1]
    s_mov_b32 s80, 1573888
    buffer_load_dwordx4 v112, s[4:7], s80 offen offset:3072 lds
    s_waitcnt vmcnt(14)
    ds_read_b64_tr_b16 a[160:161], v113 offset:8192
    ds_read_b64_tr_b16 a[162:163], v113 offset:10240
    s_add_u32 m0, s79, 24576
    s_mov_b32 s80, 1605632
    s_waitcnt lgkmcnt(2)
    buffer_load_dwordx4 v112, s[4:7], s80 offen offset:0 lds
    ds_read_b64_tr_b16 a[164:165], v114 offset:8192
    ds_read_b64_tr_b16 a[166:167], v114 offset:10240
    s_mov_b32 s80, 1633280
    buffer_load_dwordx4 v112, s[4:7], s80 offen offset:1024 lds
    ds_read_b64_tr_b16 a[168:169], v115 offset:8192
    ds_read_b64_tr_b16 a[170:171], v115 offset:10240
    s_mov_b32 s80, 1660928
    buffer_load_dwordx4 v112, s[4:7], s80 offen offset:2048 lds
    ds_read_b64_tr_b16 a[172:173], v116 offset:8192
    ds_read_b64_tr_b16 a[174:175], v116 offset:10240
    s_mov_b32 s80, 1688576
    buffer_load_dwordx4 v112, s[4:7], s80 offen offset:3072 lds
    s_waitcnt vmcnt(14)
    ds_read_b64_tr_b16 a[176:177], v113 offset:12288
    ds_read_b64_tr_b16 a[178:179], v113 offset:14336
    s_add_u32 m0, s79, 8192
    s_mov_b32 s80, 1720320
    s_waitcnt lgkmcnt(2)
    buffer_load_dwordx4 v112, s[4:7], s80 offen offset:0 lds
    ds_read_b64_tr_b16 a[180:181], v114 offset:12288
    ds_read_b64_tr_b16 a[182:183], v114 offset:14336
    s_mov_b32 s80, 1747968
    buffer_load_dwordx4 v112, s[4:7], s80 offen offset:1024 lds
    ds_read_b64_tr_b16 a[184:185], v115 offset:12288
    ds_read_b64_tr_b16 a[186:187], v115 offset:14336
    s_mov_b32 s80, 1775616
    buffer_load_dwordx4 v112, s[4:7], s80 offen offset:2048 lds
    ds_read_b64_tr_b16 a[188:189], v116 offset:12288
    ds_read_b64_tr_b16 a[190:191], v116 offset:14336
    s_mov_b32 s80, 1803264
    buffer_load_dwordx4 v112, s[4:7], s80 offen offset:3072 lds
    s_waitcnt vmcnt(12)
    ds_read_b64_tr_b16 a[192:193], v113 offset:16384
    ds_read_b64_tr_b16 a[194:195], v113 offset:18432
    s_add_u32 m0, s79, 12288
    s_mov_b32 s80, 0
    s_waitcnt lgkmcnt(2)
    buffer_load_dwordx4 v124, s[8:11], s80 offen offset:0 lds
    ds_read_b64_tr_b16 a[196:197], v114 offset:16384
    ds_read_b64_tr_b16 a[198:199], v114 offset:18432
    s_mov_b32 s80, 7168
    buffer_load_dwordx4 v124, s[8:11], s80 offen offset:1024 lds
    ds_read_b64_tr_b16 a[200:201], v115 offset:16384
    ds_read_b64_tr_b16 a[202:203], v115 offset:18432
    s_mov_b32 s80, 14336
    buffer_load_dwordx4 v124, s[8:11], s80 offen offset:2048 lds
    ds_read_b64_tr_b16 a[204:205], v116 offset:16384
    ds_read_b64_tr_b16 a[206:207], v116 offset:18432
    s_mov_b32 s80, 21504
    buffer_load_dwordx4 v124, s[8:11], s80 offen offset:3072 lds
    s_waitcnt vmcnt(12)
    ds_read_b64_tr_b16 a[208:209], v113 offset:20480
    ds_read_b64_tr_b16 a[210:211], v113 offset:22528
    s_add_u32 m0, s79, 16384
    s_mov_b32 s80, 114688
    s_waitcnt lgkmcnt(2)
    buffer_load_dwordx4 v124, s[8:11], s80 offen offset:0 lds
    ds_read_b64_tr_b16 a[212:213], v114 offset:20480
    ds_read_b64_tr_b16 a[214:215], v114 offset:22528
    s_mov_b32 s80, 121856
    buffer_load_dwordx4 v124, s[8:11], s80 offen offset:1024 lds
    ds_read_b64_tr_b16 a[216:217], v115 offset:20480
    ds_read_b64_tr_b16 a[218:219], v115 offset:22528
    s_mov_b32 s80, 129024
    buffer_load_dwordx4 v124, s[8:11], s80 offen offset:2048 lds
    ds_read_b64_tr_b16 a[220:221], v116 offset:20480
    ds_read_b64_tr_b16 a[222:223], v116 offset:22528
    buffer_load_dwordx2 v[22:23], v117, s[32:35], s88 offen offset:0 sc1
    buffer_load_dwordx2 v[24:25], v117, s[32:35], s88 offen offset:1024 sc1
    buffer_load_dwordx2 v[26:27], v117, s[32:35], s89 offen offset:0 sc1
    buffer_load_dwordx2 v[28:29], v117, s[32:35], s89 offen offset:1024 sc1
    s_mov_b32 s80, 136192
    buffer_load_dwordx4 v124, s[8:11], s80 offen offset:3072 lds
    s_waitcnt vmcnt(16)
    ds_read_b64_tr_b16 a[224:225], v113 offset:24576
    ds_read_b64_tr_b16 a[226:227], v113 offset:26624
    s_add_u32 m0, s79, 20480
    s_mov_b32 s80, 32768
    s_waitcnt lgkmcnt(2)
    buffer_load_dwordx4 v124, s[8:11], s80 offen offset:0 lds
    ds_read_b64_tr_b16 a[228:229], v114 offset:24576
    ds_read_b64_tr_b16 a[230:231], v114 offset:26624
    s_mov_b32 s80, 39936
    buffer_load_dwordx4 v124, s[8:11], s80 offen offset:1024 lds
    ds_read_b64_tr_b16 a[232:233], v115 offset:24576
    ds_read_b64_tr_b16 a[234:235], v115 offset:26624
    s_mov_b32 s80, 96256
    buffer_load_dwordx4 v124, s[8:11], s80 offen offset:2048 lds
    ds_read_b64_tr_b16 a[236:237], v116 offset:24576
    ds_read_b64_tr_b16 a[238:239], v116 offset:26624
    s_mov_b32 s80, 103424
    buffer_load_dwordx4 v124, s[8:11], s80 offen offset:3072 lds
    s_waitcnt vmcnt(16)
    ds_read_b64_tr_b16 a[240:241], v113 offset:8192
    ds_read_b64_tr_b16 a[242:243], v113 offset:10240
    s_add_u32 m0, s79, 24576
    s_mov_b32 s80, 49152
    s_waitcnt lgkmcnt(2)
    buffer_load_dwordx4 v124, s[8:11], s80 offen offset:0 lds
    ds_read_b64_tr_b16 a[244:245], v114 offset:8192
    ds_read_b64_tr_b16 a[246:247], v114 offset:10240
    s_mov_b32 s80, 56320
    buffer_load_dwordx4 v124, s[8:11], s80 offen offset:1024 lds
    ds_read_b64_tr_b16 a[248:249], v115 offset:8192
    ds_read_b64_tr_b16 a[250:251], v115 offset:10240
    s_mov_b32 s80, 161792
    buffer_load_dwordx4 v124, s[8:11], s80 offen offset:2048 lds
    ds_read_b64_tr_b16 a[252:253], v116 offset:8192
    ds_read_b64_tr_b16 a[254:255], v116 offset:10240
    s_mov_b32 s80, 168960
    buffer_load_dwordx4 v124, s[8:11], s80 offen offset:3072 lds
    s_waitcnt vmcnt(16)
    ds_read_b64_tr_b16 v[128:129], v13 offset:12288
    ds_read_b64_tr_b16 v[130:131], v13 offset:14336
    s_add_u32 m0, s79, 0
    s_mov_b32 s80, 65536
    buffer_load_dwordx4 v124, s[8:11], s80 offen offset:0 lds
    ds_read_b64_tr_b16 v[132:133], v127 offset:12288
    ds_read_b64_tr_b16 v[134:135], v127 offset:14336
    s_mov_b32 s80, 72704
    buffer_load_dwordx4 v124, s[8:11], s80 offen offset:1024 lds
    ds_read_b64_tr_b16 v[160:161], v125 offset:12288
    ds_read_b64_tr_b16 v[162:163], v125 offset:14336
    s_mov_b32 s80, 79872
    buffer_load_dwordx4 v124, s[8:11], s80 offen offset:2048 lds
    ds_read_b64_tr_b16 v[164:165], v122 offset:12288
    ds_read_b64_tr_b16 v[166:167], v122 offset:14336
    s_waitcnt vmcnt(12)
    v_max3_u32 v120, v22, v23, v24
    v_max3_u32 v121, v25, v26, v27
    v_max3_u32 v120, v120, v28, v29
    v_max_u32 v120, v120, v121
    v_cmp_eq_u32 vcc, -1, v120
    s_mov_b32 s49, 200000
    s_cbranch_vccz L3_ygot
L3_yloop:
    buffer_load_dwordx2 v[22:23], v117, s[32:35], s88 offen offset:0 sc1
    buffer_load_dwordx2 v[24:25], v117, s[32:35], s88 offen offset:1024 sc1
    buffer_load_dwordx2 v[26:27], v117, s[32:35], s89 offen offset:0 sc1
    buffer_load_dwordx2 v[28:29], v117, s[32:35], s89 offen offset:1024 sc1
    s_waitcnt vmcnt(0)
    s_sub_u32 s49, s49, 1
    s_cbranch_scc1 L3_ygot
    v_max3_u32 v120, v22, v23, v24
    v_max3_u32 v121, v25, v26, v27
    v_max3_u32 v120, v120, v28, v29
    v_max_u32 v120, v120, v121
    v_cmp_eq_u32 vcc, -1, v120
    s_cbranch_vccnz L3_yloop
L3_ygot:
    v_lshlrev_b32 v46, 16, v22
    v_and_b32 v47, s70, v22
    v_lshlrev_b32 v54, 16, v23
    v_and_b32 v55, s70, v23
    v_lshlrev_b32 v48, 16, v24
    v_and_b32 v49, s70, v24
    v_lshlrev_b32 v56, 16, v25
    v_and_b32 v57, s70, v25
    s_mov_b32 s80, 87040
    buffer_load_dwordx4 v124, s[8:11], s80 offen offset:3072 lds
    s_add_u32 m0, s79, 4096
    s_mov_b32 s80, 180224
    buffer_load_dwordx4 v124, s[8:11], s80 offen offset:0 lds
    v_lshlrev_b32 v50, 16, v26
    v_and_b32 v51, s70, v26
    v_lshlrev_b32 v58, 16, v27
    v_and_b32 v59, s70, v27
    v_lshlrev_b32 v52, 16, v28
    v_and_b32 v53, s70, v28
    v_lshlrev_b32 v60, 16, v29
    v_and_b32 v61, s70, v29
    s_mov_b32 s80, 187392
    buffer_load_dwordx4 v124, s[8:11], s80 offen offset:1024 lds
    s_mov_b32 s80, 194560
    buffer_load_dwordx4 v124, s[8:11], s80 offen offset:2048 lds
    v_pk_fma_f32 v[30:31], v[96:97], v[46:47], v[30:31]
    v_pk_fma_f32 v[32:33], v[98:99], v[48:49], v[32:33]
    v_pk_fma_f32 v[34:35], v[100:101], v[50:51], v[34:35]
    v_pk_fma_f32 v[36:37], v[102:103], v[52:53], v[36:37]
    v_pk_fma_f32 v[38:39], v[104:105], v[54:55], v[38:39]
    v_pk_fma_f32 v[40:41], v[106:107], v[56:57], v[40:41]
    v_pk_fma_f32 v[42:43], v[108:109], v[58:59], v[42:43]
    v_pk_fma_f32 v[44:45], v[110:111], v[60:61], v[44:45]
    v_pk_add_f32 v[62:63], v[30:31], v[32:33]
    v_pk_add_f32 v[64:65], v[38:39], v[40:41]
    v_pk_mul_f32 v[66:67], v[30:31], v[30:31]
    v_pk_mul_f32 v[68:69], v[38:39], v[38:39]
    v_pk_add_f32 v[62:63], v[62:63], v[34:35]
    v_pk_add_f32 v[64:65], v[64:65], v[42:43]
    v_pk_add_f32 v[62:63], v[62:63], v[36:37]
    v_pk_add_f32 v[64:65], v[64:65], v[44:45]
    v_pk_fma_f32 v[66:67], v[32:33], v[32:33], v[66:67]
    v_pk_fma_f32 v[68:69], v[40:41], v[40:41], v[68:69]
    v_pk_fma_f32 v[66:67], v[34:35], v[34:35], v[66:67]
    v_pk_fma_f32 v[68:69], v[42:43], v[42:43], v[68:69]
    v_pk_fma_f32 v[66:67], v[36:37], v[36:37], v[66:67]
    v_pk_fma_f32 v[68:69], v[44:45], v[44:45], v[68:69]
    v_add_f32 v62, v62, v63
    v_add_f32 v64, v64, v65
    v_add_f32 v66, v66, v67
    v_add_f32 v68, v68, v69
    v_permlane16_swap_b32 v62, v64
    s_nop 0
    v_permlane16_swap_b32 v66, v68
    v_add_f32 v62, v62, v64
    v_add_f32 v66, v66, v68
    s_nop 0
    v_add_f32_dpp v62, v62, v62 quad_perm:[1,0,3,2] row_mask:0xf bank_mask:0xf
    v_add_f32_dpp v66, v66, v66 quad_perm:[1,0,3,2] row_mask:0xf bank_mask:0xf
    s_nop 0
    v_add_f32_dpp v62, v62, v62 row_ror:4 row_mask:0xf bank_mask:0xf
    v_add_f32_dpp v66, v66, v66 row_ror:4 row_mask:0xf bank_mask:0xf
    s_nop 0
    v_add_f32_dpp v62, v62, v62 row_ror:8 row_mask:0xf bank_mask:0xf
    v_add_f32_dpp v66, v66, v66 row_ror:8 row_mask:0xf bank_mask:0xf
    ds_write2_b32 v11, v62, v66 offset0:64 offset1:66
    v_cvt_pk_bf16_f32 v14, v30, v31
    v_cvt_pk_bf16_f32 v15, v32, v33
    v_cvt_pk_bf16_f32 v16, v34, v35
    v_cvt_pk_bf16_f32 v17, v36, v37
    v_cvt_pk_bf16_f32 v18, v38, v39
    v_cvt_pk_bf16_f32 v19, v40, v41
    v_cvt_pk_bf16_f32 v20, v42, v43
    v_cvt_pk_bf16_f32 v21, v44, v45
    s_waitcnt lgkmcnt(0)
    s_barrier
    ds_read_b128 v[72:75], v12 offset:256
    ds_read_b128 v[76:79], v12 offset:272
    ds_read_b128 v[80:83], v12 offset:288
    ds_read_b128 v[84:87], v12 offset:304
    v_bfe_u32 v46, v1, 6, 1
LP_1:
    s_cbranch_execz LP_back
    v_bfe_u32 v47, v1, 9, 1
    v_xor_b32 v46, v46, v47
    v_bfe_u32 v47, v1, 8, 1
    v_or_b32 v46, v46, v47
    v_bfe_u32 v47, v1, 7, 1
    v_lshl_add_u32 v46, v46, 1, v47
    v_bfe_u32 v47, v1, 5, 1
    v_lshl_add_u32 v46, v46, 1, v47
    v_and_b32 v47, 16, v1
    v_lshlrev_b32 v47, v47, s68
    v_cmp_eq_u32 s[12:13], 0, v46
    s_nop 1
    v_cndmask_b32 v58, 0, v47, s[12:13]
    v_cmp_eq_u32 s[14:15], 1, v46
    s_nop 1
    v_cndmask_b32 v59, 0, v47, s[14:15]
    v_cmp_eq_u32 s[12:13], 2, v46
    s_nop 1
    v_cndmask_b32 v60, 0, v47, s[12:13]
    v_cmp_eq_u32 s[14:15], 3, v46
    s_nop 1
    v_cndmask_b32 v61, 0, v47, s[14:15]
    s_waitcnt lgkmcnt(2)
    v_pk_add_f32 v[72:73], v[72:73], v[76:77]
    v_pk_add_f32 v[74:75], v[74:75], v[78:79]
    s_waitcnt lgkmcnt(0)
    v_pk_add_f32 v[80:81], v[80:81], v[84:85]
    v_pk_add_f32 v[82:83], v[82:83], v[86:87]
    v_pk_add_f32 v[72:73], v[72:73], v[80:81]
    v_pk_add_f32 v[74:75], v[74:75], v[82:83]
    v_pk_mul_f32 v[90:91], v[72:73], s[56:57]
    v_pk_add_f32 v[74:75], v[74:75], s[58:59]
    v_pk_fma_f32 v[74:75], v[72:73], v[90:91], v[74:75] neg_lo:[1,0,0] neg_hi:[1,0,0]
    v_max_f32 v74, s58, v74
    v_max_f32 v75, s58, v75
    v_rsq_f32 v92, v74
    v_rsq_f32 v93, v75
    s_nop 0
    v_pk_mul_f32 v[92:93], v[92:93], s[62:63]
    v_pk_mul_f32 v[94:95], v[90:91], v[92:93] neg_lo:[1,0] neg_hi:[1,0]
    v_pk_fma_f32 v[96:97], v[30:31], v[92:93], v[94:95] op_sel:[0,0,0] op_sel_hi:[1,0,0]
    v_pk_fma_f32 v[98:99], v[32:33], v[92:93], v[94:95] op_sel:[0,0,0] op_sel_hi:[1,0,0]
    v_pk_fma_f32 v[100:101], v[34:35], v[92:93], v[94:95] op_sel:[0,0,0] op_sel_hi:[1,0,0]
    v_pk_fma_f32 v[102:103], v[36:37], v[92:93], v[94:95] op_sel:[0,0,0] op_sel_hi:[1,0,0]
    v_cvt_pk_bf16_f32 v96, v96, v97
    v_cvt_pk_bf16_f32 v97, v98, v99
    v_cvt_pk_bf16_f32 v98, v100, v101
    v_cvt_pk_bf16_f32 v99, v102, v103
    buffer_store_dwordx4 v[96:99], v9, s[32:35], s51 offen
    v_pk_fma_f32 v[104:105], v[38:39], v[92:93], v[94:95] op_sel:[0,1,1] op_sel_hi:[1,1,1]
    v_pk_fma_f32 v[106:107], v[40:41], v[92:93], v[94:95] op_sel:[0,1,1] op_sel_hi:[1,1,1]
    v_pk_fma_f32 v[108:109], v[42:43], v[92:93], v[94:95] op_sel:[0,1,1] op_sel_hi:[1,1,1]
    v_pk_fma_f32 v[110:111], v[44:45], v[92:93], v[94:95] op_sel:[0,1,1] op_sel_hi:[1,1,1]
    v_cvt_pk_bf16_f32 v104, v104, v105
    v_cvt_pk_bf16_f32 v105, v106, v107
    v_cvt_pk_bf16_f32 v106, v108, v109
    v_cvt_pk_bf16_f32 v107, v110, v111
    buffer_store_dwordx4 v[104:107], v9, s[32:35], s50 offen
    s_waitcnt vmcnt(17)
    ds_read_b64_tr_b16 v[136:137], v13 offset:16384
    ds_read_b64_tr_b16 v[138:139], v13 offset:18432
    ds_read_b64_tr_b16 v[140:141], v127 offset:16384
    ds_read_b64_tr_b16 v[142:143], v127 offset:18432
    ds_read_b64_tr_b16 v[168:169], v125 offset:16384
    ds_read_b64_tr_b16 v[170:171], v125 offset:18432
    ds_read_b64_tr_b16 v[172:173], v122 offset:16384
    ds_read_b64_tr_b16 v[174:175], v122 offset:18432
    s_waitcnt vmcnt(13)
    ds_read_b64_tr_b16 v[144:145], v13 offset:20480
    ds_read_b64_tr_b16 v[146:147], v13 offset:22528
    ds_read_b64_tr_b16 v[148:149], v127 offset:20480
    ds_read_b64_tr_b16 v[150:151], v127 offset:22528
    ds_read_b64_tr_b16 v[176:177], v125 offset:20480
    ds_read_b64_tr_b16 v[178:179], v125 offset:22528
    ds_read_b64_tr_b16 v[180:181], v122 offset:20480
    ds_read_b64_tr_b16 v[182:183], v122 offset:22528
    s_waitcnt vmcnt(9)
    ds_read_b64_tr_b16 v[152:153], v13 offset:24576
    ds_read_b64_tr_b16 v[154:155], v13 offset:26624
    ds_read_b64_tr_b16 v[156:157], v127 offset:24576
    ds_read_b64_tr_b16 v[158:159], v127 offset:26624
    ds_read_b64_tr_b16 v[184:185], v125 offset:24576
    ds_read_b64_tr_b16 v[186:187], v125 offset:26624
    ds_read_b64_tr_b16 v[188:189], v122 offset:24576
    ds_read_b64_tr_b16 v[190:191], v122 offset:26624
    s_add_u32 s42, s39, 0
    s_and_b32 s42, s42, 7
    s_lshl_b32 s88, s42, 13
    s_add_u32 s42, s39, 1
    s_and_b32 s42, s42, 7
    s_lshl_b32 s89, s42, 13
    s_add_u32 s42, s39, 2
    s_and_b32 s42, s42, 7
    s_lshl_b32 s90, s42, 13
    s_add_u32 s42, s39, 3
    s_and_b32 s42, s42, 7
    s_lshl_b32 s91, s42, 13
    s_add_u32 s42, s39, 4
    s_and_b32 s42, s42, 7
    s_lshl_b32 s92, s42, 13
    s_add_u32 s42, s39, 5
    s_and_b32 s42, s42, 7
    s_lshl_b32 s93, s42, 13
    s_add_u32 s42, s39, 6
    s_and_b32 s42, s42, 7
    s_lshl_b32 s94, s42, 13
    s_add_u32 s42, s39, 7
    s_and_b32 s42, s42, 7
    s_lshl_b32 s95, s42, 13
    s_waitcnt vmcnt(0)
    buffer_store_byte v0, off, s[32:35], s44 offset:0
    s_cmp_lg_u32 s48, 0
    s_cselect_b32 s49, 1, 200
L4_spin0:
    buffer_load_dword v123, v3, s[32:35], s47 offen offset:0 sc1
    s_sub_u32 s49, s49, 1
    s_cbranch_scc1 L4_slow0
    s_waitcnt vmcnt(0)
    v_cmp_ne_u32 vcc, s46, v123
    s_cbranch_vccnz L4_spin0
L4_got0:
    s_add_u32 m0, s55, 0
    s_add_u32 s76, s54, 0
    buffer_load_dwordx4 v1, s[32:35], s76 offen offset:0 sc1 lds
    buffer_load_dwordx4 v1, s[32:35], s76 offen offset:1024 sc1 lds
    s_add_u32 m0, s55, 8192
    s_add_u32 s76, s54, 8192
    buffer_load_dwordx4 v1, s[32:35], s76 offen offset:0 sc1 lds
    buffer_load_dwordx4 v1, s[32:35], s76 offen offset:1024 sc1 lds
    s_add_u32 m0, s55, 16384
    s_add_u32 s76, s54, 16384
    buffer_load_dwordx4 v1, s[32:35], s76 offen offset:0 sc1 lds
    buffer_load_dwordx4 v1, s[32:35], s76 offen offset:1024 sc1 lds
    s_add_u32 m0, s55, 24576
    s_add_u32 s76, s54, 24576
    buffer_load_dwordx4 v1, s[32:35], s76 offen offset:0 sc1 lds
    buffer_load_dwordx4 v1, s[32:35], s76 offen offset:1024 sc1 lds
    s_waitcnt vmcnt(6)
    s_barrier
    ds_read_b128 v[34:37], v2 offset:0
    ds_read_b128 v[38:41], v2 offset:2048
    ds_read_b128 v[42:45], v2 offset:4096
    ds_read_b128 v[46:49], v2 offset:6144
    s_getpc_b64 s[96:97]
L4_pc0:
    s_lshl_b32 s42, s37, 10
    v_add_u32 v30, s42, v1
    v_min_u32 v30, L3_codeend-L4_pc0-4, v30
    global_load_dword v123, v30, s[96:97]
    s_waitcnt lgkmcnt(2)
    v_mfma_f32_16x16x32_bf16 v[110:113], a[0:3], v[34:37], 0
    s_waitcnt vmcnt(5)
    s_barrier
    ds_read_b128 v[50:53], v2 offset:8192
    v_mfma_f32_16x16x32_bf16 v[110:113], a[16:19], v[38:41], v[110:113]
    s_add_u32 m0, s79, 4096
    ds_read_b128 v[54:57], v2 offset:10240
    v_mfma_f32_16x16x32_bf16 v[114:117], a[4:7], v[34:37], 0
    s_mov_b32 s80, 201728
    v_mfma_f32_16x16x32_bf16 v[114:117], a[20:23], v[38:41], v[114:117]
    buffer_load_dwordx4 v124, s[8:11], s80 offen offset:3072 lds
    v_mfma_f32_16x16x32_bf16 v[118:121], a[8:11], v[34:37], 0
    s_add_u32 m0, s79, 8192
    v_mfma_f32_16x16x32_bf16 v[118:121], a[24:27], v[38:41], v[118:121]
    s_waitcnt lgkmcnt(2)
    v_mfma_f32_16x16x32_bf16 v[110:113], a[32:35], v[42:45], v[110:113]
    s_mov_b32 s80, 147456
    ds_read_b128 v[34:37], v2 offset:12288
    v_mfma_f32_16x16x32_bf16 v[110:113], a[48:51], v[46:49], v[110:113]
    ds_read_b128 v[38:41], v2 offset:14336
    v_mfma_f32_16x16x32_bf16 v[114:117], a[36:39], v[42:45], v[114:117]
    buffer_load_dwordx4 v124, s[8:11], s80 offen offset:0 lds
    v_mfma_f32_16x16x32_bf16 v[114:117], a[52:55], v[46:49], v[114:117]
    s_mov_b32 s80, 154624
    v_mfma_f32_16x16x32_bf16 v[118:121], a[40:43], v[42:45], v[118:121]
    v_mfma_f32_16x16x32_bf16 v[118:121], a[56:59], v[46:49], v[118:121]
    s_waitcnt lgkmcnt(2)
    buffer_load_dwordx4 v124, s[8:11], s80 offen offset:1024 lds
    v_mfma_f32_16x16x32_bf16 v[110:113], a[64:67], v[50:53], v[110:113]
    s_waitcnt vmcnt(6)
    s_barrier
    ds_read_b128 v[42:45], v2 offset:16384
    v_mfma_f32_16x16x32_bf16 v[110:113], a[80:83], v[54:57], v[110:113]
    s_mov_b32 s80, 210944
    ds_read_b128 v[46:49], v2 offset:18432
    v_mfma_f32_16x16x32_bf16 v[114:117], a[68:71], v[50:53], v[114:117]
    buffer_load_dwordx4 v124, s[8:11], s80 offen offset:2048 lds
    v_mfma_f32_16x16x32_bf16 v[114:117], a[84:87], v[54:57], v[114:117]
    s_mov_b32 s80, 218112
    v_mfma_f32_16x16x32_bf16 v[118:121], a[72:75], v[50:53], v[118:121]
    v_mfma_f32_16x16x32_bf16 v[118:121], a[88:91], v[54:57], v[118:121]
    s_waitcnt lgkmcnt(2)
    buffer_load_dwordx4 v124, s[8:11], s80 offen offset:3072 lds
    v_mfma_f32_16x16x32_bf16 v[110:113], a[96:99], v[34:37], v[110:113]
    s_add_u32 m0, s79, 12288
    ds_read_b128 v[50:53], v2 offset:20480
    v_mfma_f32_16x16x32_bf16 v[110:113], a[112:115], v[38:41], v[110:113]
    s_mov_b32 s80, 128
    ds_read_b128 v[54:57], v2 offset:22528
    v_mfma_f32_16x16x32_bf16 v[114:117], a[100:103], v[34:37], v[114:117]
    buffer_load_dwordx4 v124, s[8:11], s80 offen offset:0 lds
    v_mfma_f32_16x16x32_bf16 v[114:117], a[116:119], v[38:41], v[114:117]
    s_mov_b32 s80, 7296
    v_mfma_f32_16x16x32_bf16 v[118:121], a[104:107], v[34:37], v[118:121]
    v_mfma_f32_16x16x32_bf16 v[118:121], a[120:123], v[38:41], v[118:121]
    s_waitcnt lgkmcnt(2)
    buffer_load_dwordx4 v124, s[8:11], s80 offen offset:1024 lds
    v_mfma_f32_16x16x32_bf16 v[110:113], a[128:131], v[42:45], v[110:113]
    s_waitcnt vmcnt(8)
    s_barrier
    ds_read_b128 v[34:37], v2 offset:24576
    v_mfma_f32_16x16x32_bf16 v[110:113], a[144:147], v[46:49], v[110:113]
    s_mov_b32 s80, 14464
    ds_read_b128 v[38:41], v2 offset:26624
    v_mfma_f32_16x16x32_bf16 v[114:117], a[132:135], v[42:45], v[114:117]
    buffer_load_dwordx4 v124, s[8:11], s80 offen offset:2048 lds
    v_mfma_f32_16x16x32_bf16 v[114:117], a[148:151], v[46:49], v[114:117]
    s_mov_b32 s80, 21632
    v_mfma_f32_16x16x32_bf16 v[118:121], a[136:139], v[42:45], v[118:121]
    v_mfma_f32_16x16x32_bf16 v[118:121], a[152:155], v[46:49], v[118:121]
    s_waitcnt lgkmcnt(2)
    buffer_load_dwordx4 v124, s[8:11], s80 offen offset:3072 lds
    v_mfma_f32_16x16x32_bf16 v[110:113], a[160:163], v[50:53], v[110:113]
    s_add_u32 m0, s79, 16384
    ds_read_b128 v[42:45], v2 offset:28672
    v_mfma_f32_16x16x32_bf16 v[110:113], a[176:179], v[54:57], v[110:113]
    s_mov_b32 s80, 114816
    ds_read_b128 v[46:49], v2 offset:30720
    v_xor_b32 v2, 1024, v2
    v_mfma_f32_16x16x32_bf16 v[114:117], a[164:167], v[50:53], v[114:117]
    buffer_load_dwordx4 v124, s[8:11], s80 offen offset:0 lds
    v_mfma_f32_16x16x32_bf16 v[114:117], a[180:183], v[54:57], v[114:117]
    s_mov_b32 s80, 121984
    v_mfma_f32_16x16x32_bf16 v[118:121], a[168:171], v[50:53], v[118:121]
    v_mfma_f32_16x16x32_bf16 v[118:121], a[184:187], v[54:57], v[118:121]
    s_waitcnt lgkmcnt(2)
    buffer_load_dwordx4 v124, s[8:11], s80 offen offset:1024 lds
    v_mfma_f32_16x16x32_bf16 v[110:113], a[192:195], v[34:37], v[110:113]
    s_mov_b32 s80, 129152
    ds_read_b128 v[50:53], v2 offset:0
    v_mfma_f32_16x16x32_bf16 v[110:113], a[208:211], v[38:41], v[110:113]
    ds_read_b128 v[54:57], v2 offset:2048
    v_mfma_f32_16x16x32_bf16 v[114:117], a[196:199], v[34:37], v[114:117]
    buffer_load_dwordx4 v124, s[8:11], s80 offen offset:2048 lds
    v_mfma_f32_16x16x32_bf16 v[114:117], a[212:215], v[38:41], v[114:117]
    s_mov_b32 s80, 136320
    v_mfma_f32_16x16x32_bf16 v[118:121], a[200:203], v[34:37], v[118:121]
    v_mfma_f32_16x16x32_bf16 v[118:121], a[216:219], v[38:41], v[118:121]
    s_waitcnt lgkmcnt(2)
    buffer_load_dwordx4 v124, s[8:11], s80 offen offset:3072 lds
    v_mfma_f32_16x16x32_bf16 v[110:113], a[224:227], v[42:45], v[110:113]
    s_add_u32 m0, s79, 20480
    ds_read_b128 v[34:37], v2 offset:4096
    v_mfma_f32_16x16x32_bf16 v[110:113], a[240:243], v[46:49], v[110:113]
    s_mov_b32 s80, 32896
    ds_read_b128 v[38:41], v2 offset:6144
    v_mfma_f32_16x16x32_bf16 v[114:117], a[228:231], v[42:45], v[114:117]
    buffer_load_dwordx4 v124, s[8:11], s80 offen offset:0 lds
    v_mfma_f32_16x16x32_bf16 v[114:117], a[244:247], v[46:49], v[114:117]
    s_mov_b32 s80, 40064
    v_mfma_f32_16x16x32_bf16 v[118:121], a[232:235], v[42:45], v[118:121]
    v_mfma_f32_16x16x32_bf16 v[118:121], a[248:251], v[46:49], v[118:121]
    s_waitcnt lgkmcnt(2)
    buffer_load_dwordx4 v124, s[8:11], s80 offen offset:1024 lds
    v_mfma_f32_16x16x32_bf16 v[94:97], a[0:3], v[50:53], 0
    s_mov_b32 s80, 96384
    ds_read_b128 v[42:45], v2 offset:8192
    v_mfma_f32_16x16x32_bf16 v[94:97], a[16:19], v[54:57], v[94:97]
    ds_read_b128 v[46:49], v2 offset:10240
    v_mfma_f32_16x16x32_bf16 v[98:101], a[4:7], v[50:53], 0
    buffer_load_dwordx4 v124, s[8:11], s80 offen offset:2048 lds
    v_mfma_f32_16x16x32_bf16 v[98:101], a[20:23], v[54:57], v[98:101]
    s_mov_b32 s80, 103552
    v_exp_f32 v30, -v110
    v_mfma_f32_16x16x32_bf16 v[102:105], a[8:11], v[50:53], 0
    v_exp_f32 v31, -v111
    v_mfma_f32_16x16x32_bf16 v[102:105], a[24:27], v[54:57], v[102:105]
    buffer_load_dwordx4 v124, s[8:11], s80 offen offset:3072 lds
    v_mfma_f32_16x16x32_bf16 v[106:109], a[12:15], v[50:53], 0
    s_add_u32 m0, s79, 24576
    v_exp_f32 v32, -v112
    v_mfma_f32_16x16x32_bf16 v[106:109], a[28:31], v[54:57], v[106:109]
    s_waitcnt lgkmcnt(2)
    v_exp_f32 v33, -v113
    v_mfma_f32_16x16x32_bf16 v[94:97], a[32:35], v[34:37], v[94:97]
    s_mov_b32 s80, 49280
    ds_read_b128 v[50:53], v2 offset:12288
    v_add_f32 v30, 1.0, v30
    v_mfma_f32_16x16x32_bf16 v[94:97], a[48:51], v[38:41], v[94:97]
    ds_read_b128 v[54:57], v2 offset:14336
    v_add_f32 v31, 1.0, v31
    v_mfma_f32_16x16x32_bf16 v[98:101], a[36:39], v[34:37], v[98:101]
    buffer_load_dwordx4 v124, s[8:11], s80 offen offset:0 lds
    v_mfma_f32_16x16x32_bf16 v[98:101], a[52:55], v[38:41], v[98:101]
    s_mov_b32 s80, 56448
    v_rcp_f32 v30, v30
    v_mfma_f32_16x16x32_bf16 v[102:105], a[40:43], v[34:37], v[102:105]
    v_rcp_f32 v31, v31
    v_mfma_f32_16x16x32_bf16 v[102:105], a[56:59], v[38:41], v[102:105]
    buffer_load_dwordx4 v124, s[8:11], s80 offen offset:1024 lds
    v_mfma_f32_16x16x32_bf16 v[106:109], a[44:47], v[34:37], v[106:109]
    s_mov_b32 s80, 161920
    s_waitcnt vmcnt(10)
    ds_read_b64_tr_b16 v[192:193], v13 offset:12288
    v_mul_f32 v110, v110, v30
    v_mfma_f32_16x16x32_bf16 v[106:109], a[60:63], v[38:41], v[106:109]
    s_waitcnt lgkmcnt(3)
    ds_read_b64_tr_b16 v[194:195], v13 offset:14336
    v_mul_f32 v111, v111, v31
    v_mfma_f32_16x16x32_bf16 v[94:97], a[64:67], v[42:45], v[94:97]
    ds_read_b128 v[34:37], v2 offset:16384
    v_cvt_pk_bf16_f32 v110, v110, v111
    v_mfma_f32_16x16x32_bf16 v[94:97], a[80:83], v[46:49], v[94:97]
    ds_read_b128 v[38:41], v2 offset:18432
    v_add_f32 v32, 1.0, v32
    v_mfma_f32_16x16x32_bf16 v[98:101], a[68:71], v[42:45], v[98:101]
    buffer_load_dwordx4 v124, s[8:11], s80 offen offset:2048 lds
    v_mfma_f32_16x16x32_bf16 v[98:101], a[84:87], v[46:49], v[98:101]
    s_mov_b32 s80, 169088
    ds_read_b64_tr_b16 v[196:197], v127 offset:12288
    v_add_f32 v33, 1.0, v33
    v_mfma_f32_16x16x32_bf16 v[102:105], a[72:75], v[42:45], v[102:105]
    ds_read_b64_tr_b16 v[198:199], v127 offset:14336
    v_mfma_f32_16x16x32_bf16 v[102:105], a[88:91], v[46:49], v[102:105]
    buffer_load_dwordx4 v124, s[8:11], s80 offen offset:3072 lds
    v_mfma_f32_16x16x32_bf16 v[106:109], a[76:79], v[42:45], v[106:109]
    ds_read_b64_tr_b16 v[224:225], v125 offset:12288
    v_mfma_f32_16x16x32_bf16 v[106:109], a[92:95], v[46:49], v[106:109]
    s_waitcnt lgkmcnt(7)
    ds_read_b64_tr_b16 v[226:227], v125 offset:14336
    v_mfma_f32_16x16x32_bf16 v[94:97], a[96:99], v[50:53], v[94:97]
    ds_read_b128 v[42:45], v2 offset:20480
    v_mfma_f32_16x16x32_bf16 v[94:97], a[112:115], v[54:57], v[94:97]
    ds_read_b128 v[46:49], v2 offset:22528
    v_mfma_f32_16x16x32_bf16 v[98:101], a[100:103], v[50:53], v[98:101]
    ds_read_b64_tr_b16 v[228:229], v122 offset:12288
    v_mfma_f32_16x16x32_bf16 v[98:101], a[116:119], v[54:57], v[98:101]
    ds_read_b64_tr_b16 v[230:231], v122 offset:14336
    v_mfma_f32_16x16x32_bf16 v[102:105], a[104:107], v[50:53], v[102:105]
    s_add_u32 m0, s79, 12288
    v_rcp_f32 v32, v32
    v_mfma_f32_16x16x32_bf16 v[102:105], a[120:123], v[54:57], v[102:105]
    s_mov_b32 s80, 65664
    v_rcp_f32 v33, v33
    v_mfma_f32_16x16x32_bf16 v[106:109], a[108:111], v[50:53], v[106:109]
    s_waitcnt lgkmcnt(0)
    buffer_load_dwordx4 v124, s[8:11], s80 offen offset:0 lds
    v_mfma_f32_16x16x32_bf16 v[106:109], a[124:127], v[54:57], v[106:109]
    s_mov_b32 s80, 72832
    v_exp_f32 v30, -v114
    v_mfma_f32_16x16x32_bf16 v[94:97], a[128:131], v[34:37], v[94:97]
    ds_read_b128 v[50:53], v2 offset:24576
    v_mul_f32 v112, v112, v32
    v_mfma_f32_16x16x32_bf16 v[94:97], a[144:147], v[38:41], v[94:97]
    ds_read_b128 v[54:57], v2 offset:26624
    v_mul_f32 v113, v113, v33
    v_mfma_f32_16x16x32_bf16 v[98:101], a[132:135], v[34:37], v[98:101]
    buffer_load_dwordx4 v124, s[8:11], s80 offen offset:1024 lds
    v_mfma_f32_16x16x32_bf16 v[98:101], a[148:151], v[38:41], v[98:101]
    s_mov_b32 s80, 80000
    s_waitcnt vmcnt(10)
    ds_read_b64_tr_b16 v[200:201], v13 offset:16384
    v_cvt_pk_bf16_f32 v111, v112, v113
    v_mfma_f32_16x16x32_bf16 v[102:105], a[136:139], v[34:37], v[102:105]
    ds_write_b64 v4, v[110:111] offset:0
    v_mfma_f32_16x16x32_bf16 v[102:105], a[152:155], v[38:41], v[102:105]
    buffer_load_dwordx4 v124, s[8:11], s80 offen offset:2048 lds
    v_mfma_f32_16x16x32_bf16 v[106:109], a[140:143], v[34:37], v[106:109]
    s_mov_b32 s80, 87168
    ds_read_b64_tr_b16 v[202:203], v13 offset:18432
    v_add_f32 v30, 1.0, v30
    v_mfma_f32_16x16x32_bf16 v[106:109], a[156:159], v[38:41], v[106:109]
    ds_read_b64_tr_b16 v[204:205], v127 offset:16384
    v_mfma_f32_16x16x32_bf16 v[94:97], a[160:163], v[42:45], v[94:97]
    ds_read_b128 v[34:37], v2 offset:28672
    v_mfma_f32_16x16x32_bf16 v[94:97], a[176:179], v[46:49], v[94:97]
    ds_read_b128 v[38:41], v2 offset:30720
    v_xor_b32 v2, 1024, v2
    v_mfma_f32_16x16x32_bf16 v[98:101], a[164:167], v[42:45], v[98:101]
    buffer_load_dwordx4 v124, s[8:11], s80 offen offset:3072 lds
    v_mfma_f32_16x16x32_bf16 v[98:101], a[180:183], v[46:49], v[98:101]
    ds_read_b64_tr_b16 v[206:207], v127 offset:18432
    v_mfma_f32_16x16x32_bf16 v[102:105], a[168:171], v[42:45], v[102:105]
    ds_read_b64_tr_b16 v[232:233], v125 offset:16384
    v_mfma_f32_16x16x32_bf16 v[102:105], a[184:187], v[46:49], v[102:105]
    ds_read_b64_tr_b16 v[234:235], v125 offset:18432
    v_mfma_f32_16x16x32_bf16 v[106:109], a[172:175], v[42:45], v[106:109]
    ds_read_b64_tr_b16 v[236:237], v122 offset:16384
    v_mfma_f32_16x16x32_bf16 v[106:109], a[188:191], v[46:49], v[106:109]
    s_waitcnt lgkmcnt(10)
    ds_read_b64_tr_b16 v[238:239], v122 offset:18432
    v_mfma_f32_16x16x32_bf16 v[94:97], a[192:195], v[50:53], v[94:97]
    s_add_u32 m0, s79, 16384
    v_rcp_f32 v30, v30
    v_mfma_f32_16x16x32_bf16 v[94:97], a[208:211], v[54:57], v[94:97]
    s_mov_b32 s80, 180352
    v_exp_f32 v31, -v115
    v_mfma_f32_16x16x32_bf16 v[98:101], a[196:199], v[50:53], v[98:101]
    s_waitcnt lgkmcnt(0)
    buffer_load_dwordx4 v124, s[8:11], s80 offen offset:0 lds
    v_mfma_f32_16x16x32_bf16 v[98:101], a[212:215], v[54:57], v[98:101]
    s_mov_b32 s80, 187520
    v_exp_f32 v32, -v116
    v_mfma_f32_16x16x32_bf16 v[102:105], a[200:203], v[50:53], v[102:105]
    v_exp_f32 v33, -v117
    v_mfma_f32_16x16x32_bf16 v[102:105], a[216:219], v[54:57], v[102:105]
    buffer_load_dwordx4 v124, s[8:11], s80 offen offset:1024 lds
    v_mfma_f32_16x16x32_bf16 v[106:109], a[204:207], v[50:53], v[106:109]
    s_mov_b32 s80, 194688
    s_waitcnt vmcnt(10)
    ds_read_b64_tr_b16 v[208:209], v13 offset:20480
    v_mul_f32 v114, v114, v30
    v_mfma_f32_16x16x32_bf16 v[106:109], a[220:223], v[54:57], v[106:109]
    ds_read_b64_tr_b16 v[210:211], v13 offset:22528
    v_add_f32 v31, 1.0, v31
    v_mfma_f32_16x16x32_bf16 v[94:97], a[224:227], v[34:37], v[94:97]
    buffer_load_dwordx4 v124, s[8:11], s80 offen offset:2048 lds
    v_mfma_f32_16x16x32_bf16 v[94:97], a[240:243], v[38:41], v[94:97]
    s_mov_b32 s80, 201856
    ds_read_b64_tr_b16 v[212:213], v127 offset:20480
    v_add_f32 v32, 1.0, v32
    v_mfma_f32_16x16x32_bf16 v[98:101], a[228:231], v[34:37], v[98:101]
    ds_read_b64_tr_b16 v[214:215], v127 offset:22528
    v_add_f32 v33, 1.0, v33
    v_mfma_f32_16x16x32_bf16 v[98:101], a[244:247], v[38:41], v[98:101]
    buffer_load_dwordx4 v124, s[8:11], s80 offen offset:3072 lds
    v_mfma_f32_16x16x32_bf16 v[102:105], a[232:235], v[34:37], v[102:105]
    ds_read_b64_tr_b16 v[240:241], v125 offset:20480
    v_mfma_f32_16x16x32_bf16 v[102:105], a[248:251], v[38:41], v[102:105]
    ds_read_b64_tr_b16 v[242:243], v125 offset:22528
    v_mfma_f32_16x16x32_bf16 v[106:109], a[236:239], v[34:37], v[106:109]
    ds_read_b64_tr_b16 v[244:245], v122 offset:20480
    v_mfma_f32_16x16x32_bf16 v[106:109], a[252:255], v[38:41], v[106:109]
    ds_read_b64_tr_b16 v[246:247], v122 offset:22528
    v_rcp_f32 v31, v31
    v_rcp_f32 v32, v32
    v_mul_f32 v115, v115, v31
    v_cvt_pk_bf16_f32 v114, v114, v115
    v_mul_f32 v116, v116, v32
    v_rcp_f32 v33, v33
    v_exp_f32 v30, -v118
    v_exp_f32 v31, -v119
    v_exp_f32 v32, -v120
    v_mul_f32 v117, v117, v33
    v_cvt_pk_bf16_f32 v115, v116, v117
    v_exp_f32 v33, -v121
    v_add_f32 v30, 1.0, v30
    v_add_f32 v31, 1.0, v31
    v_rcp_f32 v30, v30
    v_rcp_f32 v31, v31
    v_mul_f32 v118, v118, v30
    v_mul_f32 v119, v119, v31
    v_cvt_pk_bf16_f32 v118, v118, v119
    v_add_f32 v32, 1.0, v32
    v_rcp_f32 v32, v32
    v_add_f32 v33, 1.0, v33
    v_mul_f32 v120, v120, v32
    v_rcp_f32 v33, v33
    ds_write_b64 v4, v[114:115] offset:8
    v_mul_f32 v121, v121, v33
    v_cvt_pk_bf16_f32 v119, v120, v121
    ds_write_b64 v5, v[118:119] offset:0
    v_xor_b32 v4, 1024, v4
    v_xor_b32 v5, 1024, v5
    v_exp_f32 v30, -v94
    v_exp_f32 v31, -v95
    v_exp_f32 v32, -v96
    v_exp_f32 v33, -v97
    v_pk_add_f32 v[30:31], v[30:31], 1.0 op_sel_hi:[1,0]
    v_pk_add_f32 v[32:33], v[32:33], 1.0 op_sel_hi:[1,0]
    v_rcp_f32 v30, v30
    v_rcp_f32 v31, v31
    v_rcp_f32 v32, v32
    v_rcp_f32 v33, v33
    v_pk_mul_f32 v[94:95], v[94:95], v[30:31]
    v_pk_mul_f32 v[96:97], v[96:97], v[32:33]
    v_cvt_pk_bf16_f32 v94, v94, v95
    v_cvt_pk_bf16_f32 v95, v96, v97
    ds_write_b64 v4, v[94:95] offset:0
    s_add_u32 m0, s79, 20480
    s_mov_b32 s80, 147584
    s_waitcnt lgkmcnt(3)
    buffer_load_dwordx4 v124, s[8:11], s80 offen offset:0 lds
    v_exp_f32 v30, -v98
    v_exp_f32 v31, -v99
    v_exp_f32 v32, -v100
    v_exp_f32 v33, -v101
    v_pk_add_f32 v[30:31], v[30:31], 1.0 op_sel_hi:[1,0]
    v_pk_add_f32 v[32:33], v[32:33], 1.0 op_sel_hi:[1,0]
    v_rcp_f32 v30, v30
    v_rcp_f32 v31, v31
    v_rcp_f32 v32, v32
    v_rcp_f32 v33, v33
    v_pk_mul_f32 v[98:99], v[98:99], v[30:31]
    v_pk_mul_f32 v[100:101], v[100:101], v[32:33]
    v_cvt_pk_bf16_f32 v98, v98, v99
    v_cvt_pk_bf16_f32 v99, v100, v101
    ds_write_b64 v4, v[98:99] offset:8
    s_mov_b32 s80, 154752
    buffer_load_dwordx4 v124, s[8:11], s80 offen offset:1024 lds
    s_waitcnt vmcnt(10)
    ds_read_b64_tr_b16 v[216:217], v13 offset:24576
    ds_read_b64_tr_b16 v[218:219], v13 offset:26624
    v_exp_f32 v30, -v102
    v_exp_f32 v31, -v103
    v_exp_f32 v32, -v104
    v_exp_f32 v33, -v105
    v_pk_add_f32 v[30:31], v[30:31], 1.0 op_sel_hi:[1,0]
    v_pk_add_f32 v[32:33], v[32:33], 1.0 op_sel_hi:[1,0]
    v_rcp_f32 v30, v30
    v_rcp_f32 v31, v31
    v_rcp_f32 v32, v32
    v_rcp_f32 v33, v33
    v_pk_mul_f32 v[102:103], v[102:103], v[30:31]
    v_pk_mul_f32 v[104:105], v[104:105], v[32:33]
    v_cvt_pk_bf16_f32 v102, v102, v103
    v_cvt_pk_bf16_f32 v103, v104, v105
    ds_write_b64 v5, v[102:103] offset:0
    v_xor_b32 v4, 1024, v4
    v_xor_b32 v5, 1024, v5
    s_mov_b32 s80, 211072
    buffer_load_dwordx4 v124, s[8:11], s80 offen offset:2048 lds
    ds_read_b64_tr_b16 v[220:221], v127 offset:24576
    ds_read_b64_tr_b16 v[222:223], v127 offset:26624
    v_exp_f32 v30, -v106
    v_exp_f32 v31, -v107
    v_exp_f32 v32, -v108
    v_exp_f32 v33, -v109
    v_pk_add_f32 v[30:31], v[30:31], 1.0 op_sel_hi:[1,0]
    v_pk_add_f32 v[32:33], v[32:33], 1.0 op_sel_hi:[1,0]
    v_rcp_f32 v30, v30
    v_rcp_f32 v31, v31
    v_rcp_f32 v32, v32
    v_rcp_f32 v33, v33
    v_pk_mul_f32 v[106:107], v[106:107], v[30:31]
    v_pk_mul_f32 v[108:109], v[108:109], v[32:33]
    v_cvt_pk_bf16_f32 v106, v106, v107
    v_cvt_pk_bf16_f32 v107, v108, v109
    ds_write_b64 v6, v[106:107] offset:0
    s_mov_b32 s80, 218240
    buffer_load_dwordx4 v124, s[8:11], s80 offen offset:3072 lds
    ds_read_b64_tr_b16 v[248:249], v125 offset:24576
    ds_read_b64_tr_b16 v[250:251], v125 offset:26624
    s_waitcnt lgkmcnt(0)
    s_barrier
    ds_read_b128 v[110:113], v1 offset:32768
    ds_read_b64_tr_b16 v[114:115], v13 offset:0
    ds_read_b64_tr_b16 v[116:117], v13 offset:2048
    ds_read_b128 v[118:121], v1 offset:34816
    ds_read_b128 v[42:45], v1 offset:33792
    ds_read_b128 v[46:49], v1 offset:35840
    s_waitcnt lgkmcnt(5)
    v_mfma_f32_16x16x32_bf16 v[62:65], v[128:131], v[110:113], 0
    s_waitcnt lgkmcnt(2)
    ds_read_b64_tr_b16 v[50:51], v127 offset:0
    ds_read_b64_tr_b16 v[52:53], v127 offset:2048
    v_mfma_f32_16x16x32_bf16 v[62:65], v[114:117], v[118:121], v[62:65]
    s_waitcnt lgkmcnt(3)
    ds_read_b128 v[54:57], v1 offset:36864
    v_mfma_f32_16x16x32_bf16 v[70:73], v[128:131], v[42:45], 0
    s_waitcnt lgkmcnt(3)
    ds_read_b64_tr_b16 v[94:95], v13 offset:4096
    ds_read_b64_tr_b16 v[96:97], v13 offset:6144
    v_mfma_f32_16x16x32_bf16 v[70:73], v[114:117], v[46:49], v[70:73]
    s_add_u32 m0, s55, 0
    ds_read_b128 v[98:101], v1 offset:38912
    v_mfma_f32_16x16x32_bf16 v[74:77], v[132:135], v[42:45], 0
    s_waitcnt lgkmcnt(4)
    ds_read_b128 v[102:105], v1 offset:37888
    v_mfma_f32_16x16x32_bf16 v[74:77], v[50:53], v[46:49], v[74:77]
    s_add_u32 s76, s54, 32768
    ds_read_b128 v[106:109], v1 offset:39936
    v_mfma_f32_16x16x32_bf16 v[66:69], v[132:135], v[110:113], 0
    ds_read_b64_tr_b16 v[34:35], v127 offset:4096
    ds_read_b64_tr_b16 v[36:37], v127 offset:6144
    v_mfma_f32_16x16x32_bf16 v[66:69], v[50:53], v[118:121], v[66:69]
    s_waitcnt lgkmcnt(7)
    buffer_load_dwordx4 v1, s[32:35], s76 offen offset:0 sc1 lds
    v_mfma_f32_16x16x32_bf16 v[62:65], v[136:139], v[54:57], v[62:65]
    s_waitcnt lgkmcnt(4)
    ds_read_b128 v[38:41], v1 offset:40960
    v_mfma_f32_16x16x32_bf16 v[62:65], v[94:97], v[98:101], v[62:65]
    s_waitcnt lgkmcnt(4)
    ds_read_b64_tr_b16 v[114:115], v13 offset:8192
    ds_read_b64_tr_b16 v[116:117], v13 offset:10240
    v_mfma_f32_16x16x32_bf16 v[70:73], v[136:139], v[102:105], v[70:73]
LP_2:
    s_cbranch_execz LP_3
    s_waitcnt lgkmcnt(5)
    ds_read_b128 v[42:45], v1 offset:43008
    v_mfma_f32_16x16x32_bf16 v[70:73], v[94:97], v[106:109], v[70:73]
    ds_read_b128 v[110:113], v1 offset:41984
    v_mfma_f32_16x16x32_bf16 v[74:77], v[140:143], v[102:105], v[74:77]
    s_waitcnt lgkmcnt(5)
    ds_read_b128 v[50:53], v1 offset:44032
    v_mfma_f32_16x16x32_bf16 v[74:77], v[34:37], v[106:109], v[74:77]
    ds_read_b64_tr_b16 v[94:95], v127 offset:8192
    ds_read_b64_tr_b16 v[96:97], v127 offset:10240
    v_mfma_f32_16x16x32_bf16 v[66:69], v[140:143], v[54:57], v[66:69]
    buffer_load_dwordx4 v1, s[32:35], s76 offen offset:1024 sc1 lds
    v_mfma_f32_16x16x32_bf16 v[66:69], v[34:37], v[98:101], v[66:69]
    s_waitcnt lgkmcnt(7)
    ds_read_b64_tr_b16 v[252:253], v122 offset:24576
    ds_read_b64_tr_b16 v[254:255], v122 offset:26624
    v_mfma_f32_16x16x32_bf16 v[62:65], v[144:147], v[38:41], v[62:65]
    s_waitcnt lgkmcnt(6)
    ds_read_b128 v[102:105], v1 offset:45056
    v_mfma_f32_16x16x32_bf16 v[62:65], v[114:117], v[42:45], v[62:65]
    s_waitcnt lgkmcnt(6)
    ds_read_b128 v[54:57], v1 offset:46080
    v_mfma_f32_16x16x32_bf16 v[70:73], v[144:147], v[110:113], v[70:73]
    s_waitcnt lgkmcnt(6)
    s_add_u32 m0, s55, 8192
    s_add_u32 s76, s54, 40960
    buffer_load_dwordx4 v1, s[32:35], s76 offen offset:0 sc1 lds
    v_mfma_f32_16x16x32_bf16 v[70:73], v[114:117], v[50:53], v[70:73]
    ds_read_b128 v[34:37], v1 offset:32768
    v_mfma_f32_16x16x32_bf16 v[74:77], v[148:151], v[110:113], v[74:77]
    s_waitcnt lgkmcnt(5)
    buffer_load_dwordx4 v1, s[32:35], s76 offen offset:1024 sc1 lds
    v_mfma_f32_16x16x32_bf16 v[74:77], v[94:97], v[50:53], v[74:77]
    s_add_u32 m0, s55, 16384
    ds_read_b64_tr_b16 v[114:115], v125 offset:0
    ds_read_b64_tr_b16 v[116:117], v125 offset:2048
    v_mfma_f32_16x16x32_bf16 v[66:69], v[148:151], v[38:41], v[66:69]
    s_add_u32 s76, s54, 49152
    ds_read_b128 v[110:113], v1 offset:33792
    v_mfma_f32_16x16x32_bf16 v[66:69], v[94:97], v[42:45], v[66:69]
    s_waitcnt lgkmcnt(5)
    buffer_load_dwordx4 v1, s[32:35], s76 offen offset:0 sc1 lds
    v_mfma_f32_16x16x32_bf16 v[62:65], v[152:155], v[102:105], v[62:65]
    s_waitcnt lgkmcnt(4)
    ds_read_b64_tr_b16 v[38:39], v122 offset:0
    ds_read_b64_tr_b16 v[40:41], v122 offset:2048
    v_mfma_f32_16x16x32_bf16 v[70:73], v[152:155], v[54:57], v[70:73]
    buffer_load_dwordx4 v1, s[32:35], s76 offen offset:1024 sc1 lds
    v_mfma_f32_16x16x32_bf16 v[74:77], v[156:159], v[54:57], v[74:77]
    s_add_u32 m0, s55, 24576
    ds_read_b128 v[94:97], v1 offset:36864
    v_mfma_f32_16x16x32_bf16 v[66:69], v[156:159], v[102:105], v[66:69]
    s_waitcnt lgkmcnt(6)
    s_add_u32 s76, s54, 57344
    buffer_load_dwordx4 v1, s[32:35], s76 offen offset:0 sc1 lds
    v_mfma_f32_16x16x32_bf16 v[78:81], v[160:163], v[34:37], 0
    s_waitcnt lgkmcnt(4)
    ds_read_b64_tr_b16 v[54:55], v125 offset:4096
    ds_read_b64_tr_b16 v[56:57], v125 offset:6144
    v_mfma_f32_16x16x32_bf16 v[78:81], v[114:117], v[118:121], v[78:81]
    s_waitcnt lgkmcnt(5)
    buffer_load_dwordx4 v1, s[32:35], s76 offen offset:1024 sc1 lds
    v_mfma_f32_16x16x32_bf16 v[86:89], v[160:163], v[110:113], 0
    ds_read_b128 v[102:105], v1 offset:37888
    v_cvt_pk_bf16_f32 v70, v70, v71
    v_mfma_f32_16x16x32_bf16 v[86:89], v[114:117], v[46:49], v[86:89]
    ds_read_b64_tr_b16 v[114:115], v122 offset:4096
    ds_read_b64_tr_b16 v[116:117], v122 offset:6144
    v_mfma_f32_16x16x32_bf16 v[90:93], v[164:167], v[110:113], 0
    s_waitcnt lgkmcnt(6)
    v_cvt_pk_bf16_f32 v71, v72, v73
    v_cvt_pk_bf16_f32 v72, v74, v75
    v_mfma_f32_16x16x32_bf16 v[90:93], v[38:41], v[46:49], v[90:93]
    v_cvt_pk_bf16_f32 v73, v76, v77
    v_cvt_pk_bf16_f32 v62, v62, v63
    v_mfma_f32_16x16x32_bf16 v[82:85], v[164:167], v[34:37], 0
    buffer_store_dwordx4 v[70:73], v7, s[32:35], s53 offen offset:0 sc1
    v_mfma_f32_16x16x32_bf16 v[82:85], v[38:41], v[118:121], v[82:85]
    s_waitcnt lgkmcnt(5)
    ds_read_b128 v[110:113], v1 offset:40960
    v_cvt_pk_bf16_f32 v63, v64, v65
    v_mfma_f32_16x16x32_bf16 v[78:81], v[168:171], v[94:97], v[78:81]
    s_waitcnt lgkmcnt(4)
    ds_read_b64_tr_b16 v[34:35], v125 offset:8192
    ds_read_b64_tr_b16 v[36:37], v125 offset:10240
    v_mfma_f32_16x16x32_bf16 v[78:81], v[54:57], v[98:101], v[78:81]
    s_waitcnt lgkmcnt(5)
    v_cvt_pk_bf16_f32 v64, v66, v67
    v_cvt_pk_bf16_f32 v65, v68, v69
    v_mfma_f32_16x16x32_bf16 v[86:89], v[168:171], v[102:105], v[86:89]
    buffer_store_dwordx4 v[62:65], v7, s[32:35], s52 offen offset:0 sc1
    v_mfma_f32_16x16x32_bf16 v[86:89], v[54:57], v[106:109], v[86:89]
    ds_read_b128 v[38:41], v1 offset:41984
    v_mfma_f32_16x16x32_bf16 v[90:93], v[172:175], v[102:105], v[90:93]
    s_waitcnt lgkmcnt(4)
    ds_read_b64_tr_b16 v[54:55], v122 offset:8192
    ds_read_b64_tr_b16 v[56:57], v122 offset:10240
    v_mfma_f32_16x16x32_bf16 v[90:93], v[114:117], v[106:109], v[90:93]
    ds_read_b128 v[102:105], v1 offset:45056
    v_mfma_f32_16x16x32_bf16 v[82:85], v[172:175], v[94:97], v[82:85]
    ds_read_b128 v[94:97], v1 offset:46080
    v_mfma_f32_16x16x32_bf16 v[82:85], v[114:117], v[98:101], v[82:85]
    s_waitcnt lgkmcnt(7)
    ds_read_b128 v[114:117], v1 offset:32768
    v_mfma_f32_16x16x32_bf16 v[78:81], v[176:179], v[110:113], v[78:81]
    s_waitcnt lgkmcnt(6)
    v_mfma_f32_16x16x32_bf16 v[78:81], v[34:37], v[42:45], v[78:81]
    s_waitcnt lgkmcnt(5)
    v_mfma_f32_16x16x32_bf16 v[86:89], v[176:179], v[38:41], v[86:89]
    v_mfma_f32_16x16x32_bf16 v[86:89], v[34:37], v[50:53], v[86:89]
    s_waitcnt vmcnt(18)
    ds_read_b64_tr_b16 v[34:35], v13 offset:12288
    ds_read_b64_tr_b16 v[36:37], v13 offset:14336
    v_mfma_f32_16x16x32_bf16 v[90:93], v[180:183], v[38:41], v[90:93]
    s_waitcnt lgkmcnt(5)
    ds_read_b128 v[38:41], v1 offset:33792
    v_mfma_f32_16x16x32_bf16 v[90:93], v[54:57], v[50:53], v[90:93]
    v_mfma_f32_16x16x32_bf16 v[82:85], v[180:183], v[110:113], v[82:85]
    ds_read_b64_tr_b16 v[110:111], v127 offset:12288
    ds_read_b64_tr_b16 v[112:113], v127 offset:14336
    v_mfma_f32_16x16x32_bf16 v[82:85], v[54:57], v[42:45], v[82:85]
    s_waitcnt lgkmcnt(7)
    ds_read_b128 v[54:57], v1 offset:36864
    v_mfma_f32_16x16x32_bf16 v[78:81], v[184:187], v[102:105], v[78:81]
    s_waitcnt lgkmcnt(7)
    v_mfma_f32_16x16x32_bf16 v[86:89], v[184:187], v[94:97], v[86:89]
    v_mfma_f32_16x16x32_bf16 v[90:93], v[188:191], v[94:97], v[90:93]
    s_waitcnt vmcnt(14)
    ds_read_b64_tr_b16 v[94:95], v13 offset:16384
    ds_read_b64_tr_b16 v[96:97], v13 offset:18432
    v_mfma_f32_16x16x32_bf16 v[82:85], v[188:191], v[102:105], v[82:85]
    s_waitcnt lgkmcnt(8)
    ds_read_b128 v[102:105], v1 offset:37888
    v_mfma_f32_16x16x32_bf16 v[62:65], v[192:195], v[114:117], 0
    s_waitcnt lgkmcnt(7)
    v_mfma_f32_16x16x32_bf16 v[62:65], v[34:37], v[118:121], v[62:65]
    s_waitcnt lgkmcnt(6)
    v_mfma_f32_16x16x32_bf16 v[70:73], v[192:195], v[38:41], 0
    v_cvt_pk_bf16_f32 v86, v86, v87
    v_cvt_pk_bf16_f32 v87, v88, v89
    v_mfma_f32_16x16x32_bf16 v[70:73], v[34:37], v[46:49], v[70:73]
    ds_read_b64_tr_b16 v[34:35], v127 offset:16384
    ds_read_b64_tr_b16 v[36:37], v127 offset:18432
    v_mfma_f32_16x16x32_bf16 v[74:77], v[196:199], v[38:41], 0
    s_waitcnt lgkmcnt(6)
    ds_read_b128 v[38:41], v1 offset:40960
    v_cvt_pk_bf16_f32 v88, v90, v91
    v_mfma_f32_16x16x32_bf16 v[74:77], v[110:113], v[46:49], v[74:77]
    v_cvt_pk_bf16_f32 v89, v92, v93
    v_cvt_pk_bf16_f32 v78, v78, v79
    v_mfma_f32_16x16x32_bf16 v[66:69], v[196:199], v[114:117], 0
    buffer_store_dwordx4 v[86:89], v7, s[32:35], s53 offen offset:256 sc1
    v_mfma_f32_16x16x32_bf16 v[66:69], v[110:113], v[118:121], v[66:69]
    s_waitcnt lgkmcnt(6)
    s_waitcnt vmcnt(11)
    ds_read_b64_tr_b16 v[114:115], v13 offset:20480
    ds_read_b64_tr_b16 v[116:117], v13 offset:22528
    v_mfma_f32_16x16x32_bf16 v[62:65], v[200:203], v[54:57], v[62:65]
    s_waitcnt lgkmcnt(6)
    v_cvt_pk_bf16_f32 v79, v80, v81
    v_cvt_pk_bf16_f32 v80, v82, v83
    v_mfma_f32_16x16x32_bf16 v[62:65], v[94:97], v[98:101], v[62:65]
    s_waitcnt lgkmcnt(5)
    v_cvt_pk_bf16_f32 v81, v84, v85
    v_mfma_f32_16x16x32_bf16 v[70:73], v[200:203], v[102:105], v[70:73]
    buffer_store_dwordx4 v[78:81], v7, s[32:35], s52 offen offset:256 sc1
    v_mfma_f32_16x16x32_bf16 v[70:73], v[94:97], v[106:109], v[70:73]
    ds_read_b128 v[110:113], v1 offset:41984
    v_mfma_f32_16x16x32_bf16 v[74:77], v[204:207], v[102:105], v[74:77]
    s_waitcnt lgkmcnt(4)
    ds_read_b64_tr_b16 v[94:95], v127 offset:20480
    ds_read_b64_tr_b16 v[96:97], v127 offset:22528
    v_mfma_f32_16x16x32_bf16 v[74:77], v[34:37], v[106:109], v[74:77]
    ds_read_b128 v[102:105], v1 offset:45056
    v_mfma_f32_16x16x32_bf16 v[66:69], v[204:207], v[54:57], v[66:69]
    ds_read_b128 v[54:57], v1 offset:46080
    v_mfma_f32_16x16x32_bf16 v[66:69], v[34:37], v[98:101], v[66:69]
    s_waitcnt lgkmcnt(7)
    ds_read_b128 v[34:37], v1 offset:32768
    v_mfma_f32_16x16x32_bf16 v[62:65], v[208:211], v[38:41], v[62:65]
    s_waitcnt lgkmcnt(6)
    v_mfma_f32_16x16x32_bf16 v[62:65], v[114:117], v[42:45], v[62:65]
    s_waitcnt lgkmcnt(5)
    v_mfma_f32_16x16x32_bf16 v[70:73], v[208:211], v[110:113], v[70:73]
    v_mfma_f32_16x16x32_bf16 v[70:73], v[114:117], v[50:53], v[70:73]
    ds_read_b64_tr_b16 v[114:115], v125 offset:12288
    ds_read_b64_tr_b16 v[116:117], v125 offset:14336
    v_mfma_f32_16x16x32_bf16 v[74:77], v[212:215], v[110:113], v[74:77]
    s_waitcnt lgkmcnt(5)
    ds_read_b128 v[110:113], v1 offset:33792
    v_mfma_f32_16x16x32_bf16 v[74:77], v[94:97], v[50:53], v[74:77]
    v_mfma_f32_16x16x32_bf16 v[66:69], v[212:215], v[38:41], v[66:69]
    ds_read_b64_tr_b16 v[38:39], v122 offset:12288
    ds_read_b64_tr_b16 v[40:41], v122 offset:14336
    v_mfma_f32_16x16x32_bf16 v[66:69], v[94:97], v[42:45], v[66:69]
    s_waitcnt lgkmcnt(7)
    ds_read_b128 v[94:97], v1 offset:36864
    v_mfma_f32_16x16x32_bf16 v[62:65], v[216:219], v[102:105], v[62:65]
    s_waitcnt lgkmcnt(7)
    v_mfma_f32_16x16x32_bf16 v[70:73], v[216:219], v[54:57], v[70:73]
    v_mfma_f32_16x16x32_bf16 v[74:77], v[220:223], v[54:57], v[74:77]
    ds_read_b64_tr_b16 v[54:55], v125 offset:16384
    ds_read_b64_tr_b16 v[56:57], v125 offset:18432
    v_mfma_f32_16x16x32_bf16 v[66:69], v[220:223], v[102:105], v[66:69]
    s_waitcnt lgkmcnt(8)
    ds_read_b128 v[102:105], v1 offset:37888
    v_mfma_f32_16x16x32_bf16 v[78:81], v[224:227], v[34:37], 0
    s_waitcnt lgkmcnt(7)
    v_mfma_f32_16x16x32_bf16 v[78:81], v[114:117], v[118:121], v[78:81]
    s_waitcnt lgkmcnt(6)
    v_mfma_f32_16x16x32_bf16 v[86:89], v[224:227], v[110:113], 0
    v_cvt_pk_bf16_f32 v70, v70, v71
    v_cvt_pk_bf16_f32 v71, v72, v73
    v_mfma_f32_16x16x32_bf16 v[86:89], v[114:117], v[46:49], v[86:89]
    ds_read_b64_tr_b16 v[114:115], v122 offset:16384
    ds_read_b64_tr_b16 v[116:117], v122 offset:18432
    v_mfma_f32_16x16x32_bf16 v[90:93], v[228:231], v[110:113], 0
    s_waitcnt lgkmcnt(6)
    ds_read_b128 v[110:113], v1 offset:40960
    v_cvt_pk_bf16_f32 v72, v74, v75
    v_mfma_f32_16x16x32_bf16 v[90:93], v[38:41], v[46:49], v[90:93]
    v_cvt_pk_bf16_f32 v73, v76, v77
    v_cvt_pk_bf16_f32 v62, v62, v63
    v_mfma_f32_16x16x32_bf16 v[82:85], v[228:231], v[34:37], 0
    buffer_store_dwordx4 v[70:73], v7, s[32:35], s53 offen offset:512 sc1
    v_mfma_f32_16x16x32_bf16 v[82:85], v[38:41], v[118:121], v[82:85]
    s_waitcnt lgkmcnt(6)
    ds_read_b64_tr_b16 v[46:47], v125 offset:20480
    ds_read_b64_tr_b16 v[48:49], v125 offset:22528
    v_mfma_f32_16x16x32_bf16 v[78:81], v[232:235], v[94:97], v[78:81]
    s_waitcnt lgkmcnt(6)
    v_cvt_pk_bf16_f32 v63, v64, v65
    v_cvt_pk_bf16_f32 v64, v66, v67
    v_mfma_f32_16x16x32_bf16 v[78:81], v[54:57], v[98:101], v[78:81]
    s_waitcnt lgkmcnt(5)
    v_cvt_pk_bf16_f32 v65, v68, v69
    v_mfma_f32_16x16x32_bf16 v[86:89], v[232:235], v[102:105], v[86:89]
    buffer_store_dwordx4 v[62:65], v7, s[32:35], s52 offen offset:512 sc1
    v_mfma_f32_16x16x32_bf16 v[86:89], v[54:57], v[106:109], v[86:89]
    ds_read_b128 v[34:37], v1 offset:41984
    v_mfma_f32_16x16x32_bf16 v[90:93], v[236:239], v[102:105], v[90:93]
    s_waitcnt lgkmcnt(4)
    ds_read_b64_tr_b16 v[38:39], v122 offset:20480
    ds_read_b64_tr_b16 v[40:41], v122 offset:22528
    v_mfma_f32_16x16x32_bf16 v[90:93], v[114:117], v[106:109], v[90:93]
    ds_read_b128 v[118:121], v1 offset:45056
    v_mfma_f32_16x16x32_bf16 v[82:85], v[236:239], v[94:97], v[82:85]
    ds_read_b128 v[54:57], v1 offset:46080
    v_mfma_f32_16x16x32_bf16 v[82:85], v[114:117], v[98:101], v[82:85]
    s_waitcnt lgkmcnt(7)
    v_mfma_f32_16x16x32_bf16 v[78:81], v[240:243], v[110:113], v[78:81]
    s_waitcnt lgkmcnt(5)
    v_mfma_f32_16x16x32_bf16 v[78:81], v[46:49], v[42:45], v[78:81]
    s_waitcnt lgkmcnt(4)
    v_mfma_f32_16x16x32_bf16 v[86:89], v[240:243], v[34:37], v[86:89]
    v_mfma_f32_16x16x32_bf16 v[86:89], v[46:49], v[50:53], v[86:89]
    v_mfma_f32_16x16x32_bf16 v[90:93], v[244:247], v[34:37], v[90:93]
    s_waitcnt lgkmcnt(2)
    v_mfma_f32_16x16x32_bf16 v[90:93], v[38:41], v[50:53], v[90:93]
    v_mfma_f32_16x16x32_bf16 v[82:85], v[244:247], v[110:113], v[82:85]
    v_mfma_f32_16x16x32_bf16 v[82:85], v[38:41], v[42:45], v[82:85]
    s_waitcnt lgkmcnt(1)
    v_mfma_f32_16x16x32_bf16 v[78:81], v[248:251], v[118:121], v[78:81]
    s_waitcnt lgkmcnt(0)
    v_mfma_f32_16x16x32_bf16 v[86:89], v[248:251], v[54:57], v[86:89]
    v_mfma_f32_16x16x32_bf16 v[90:93], v[252:255], v[54:57], v[90:93]
    v_mfma_f32_16x16x32_bf16 v[82:85], v[252:255], v[118:121], v[82:85]
    v_bfe_u32 v124, v1, 6, 2
    v_and_b32 v30, 0xff, v7
    v_lshl_add_u32 v124, v124, 10, v30
    s_waitcnt vmcnt(12)
    s_barrier
    ds_read_b128 v[34:37], v2 offset:0
    ds_read_b128 v[38:41], v2 offset:2048
    ds_read_b128 v[42:45], v2 offset:4096
    ds_read_b128 v[46:49], v2 offset:6144
    v_cvt_pk_bf16_f32 v86, v86, v87
    v_cvt_pk_bf16_f32 v87, v88, v89
    v_cvt_pk_bf16_f32 v88, v90, v91
    v_cvt_pk_bf16_f32 v89, v92, v93
    buffer_store_dwordx4 v[86:89], v124, s[32:35], s26 offen
    v_cvt_pk_bf16_f32 v78, v78, v79
    v_cvt_pk_bf16_f32 v79, v80, v81
    v_cvt_pk_bf16_f32 v80, v82, v83
    v_cvt_pk_bf16_f32 v81, v84, v85
    buffer_store_dwordx4 v[78:81], v124, s[32:35], s81 offen
    s_waitcnt lgkmcnt(2)
    v_mfma_f32_16x16x32_bf16 v[110:113], a[0:3], v[34:37], 0
    s_waitcnt vmcnt(12)
    s_barrier
    ds_read_b128 v[50:53], v2 offset:8192
    v_mfma_f32_16x16x32_bf16 v[110:113], a[16:19], v[38:41], v[110:113]
    ds_read_b128 v[54:57], v2 offset:10240
    v_mfma_f32_16x16x32_bf16 v[114:117], a[4:7], v[34:37], 0
    v_mfma_f32_16x16x32_bf16 v[114:117], a[20:23], v[38:41], v[114:117]
    v_mfma_f32_16x16x32_bf16 v[118:121], a[8:11], v[34:37], 0
    v_mfma_f32_16x16x32_bf16 v[118:121], a[24:27], v[38:41], v[118:121]
    s_waitcnt lgkmcnt(2)
    v_mfma_f32_16x16x32_bf16 v[110:113], a[32:35], v[42:45], v[110:113]
    ds_read_b128 v[34:37], v2 offset:12288
    v_mfma_f32_16x16x32_bf16 v[110:113], a[48:51], v[46:49], v[110:113]
    ds_read_b128 v[38:41], v2 offset:14336
    v_mfma_f32_16x16x32_bf16 v[114:117], a[36:39], v[42:45], v[114:117]
    v_mfma_f32_16x16x32_bf16 v[114:117], a[52:55], v[46:49], v[114:117]
    v_mfma_f32_16x16x32_bf16 v[118:121], a[40:43], v[42:45], v[118:121]
    v_mfma_f32_16x16x32_bf16 v[118:121], a[56:59], v[46:49], v[118:121]
    s_waitcnt lgkmcnt(2)
    v_mfma_f32_16x16x32_bf16 v[110:113], a[64:67], v[50:53], v[110:113]
    s_waitcnt vmcnt(10)
    s_barrier
    ds_read_b128 v[42:45], v2 offset:16384
    v_mfma_f32_16x16x32_bf16 v[110:113], a[80:83], v[54:57], v[110:113]
    ds_read_b128 v[46:49], v2 offset:18432
    v_mfma_f32_16x16x32_bf16 v[114:117], a[68:71], v[50:53], v[114:117]
    v_mfma_f32_16x16x32_bf16 v[114:117], a[84:87], v[54:57], v[114:117]
    v_mfma_f32_16x16x32_bf16 v[118:121], a[72:75], v[50:53], v[118:121]
    v_mfma_f32_16x16x32_bf16 v[118:121], a[88:91], v[54:57], v[118:121]
    s_waitcnt lgkmcnt(2)
    v_mfma_f32_16x16x32_bf16 v[110:113], a[96:99], v[34:37], v[110:113]
    ds_read_b128 v[50:53], v2 offset:20480
    v_mfma_f32_16x16x32_bf16 v[110:113], a[112:115], v[38:41], v[110:113]
    ds_read_b128 v[54:57], v2 offset:22528
    v_mfma_f32_16x16x32_bf16 v[114:117], a[100:103], v[34:37], v[114:117]
    v_mfma_f32_16x16x32_bf16 v[114:117], a[116:119], v[38:41], v[114:117]
    v_mfma_f32_16x16x32_bf16 v[118:121], a[104:107], v[34:37], v[118:121]
    v_mfma_f32_16x16x32_bf16 v[118:121], a[120:123], v[38:41], v[118:121]
    s_waitcnt lgkmcnt(2)
    v_mfma_f32_16x16x32_bf16 v[110:113], a[128:131], v[42:45], v[110:113]
    s_waitcnt vmcnt(8)
    s_barrier
    ds_read_b128 v[34:37], v2 offset:24576
    v_mfma_f32_16x16x32_bf16 v[110:113], a[144:147], v[46:49], v[110:113]
    ds_read_b128 v[38:41], v2 offset:26624
    v_mfma_f32_16x16x32_bf16 v[114:117], a[132:135], v[42:45], v[114:117]
    v_mfma_f32_16x16x32_bf16 v[114:117], a[148:151], v[46:49], v[114:117]
    v_mfma_f32_16x16x32_bf16 v[118:121], a[136:139], v[42:45], v[118:121]
    s_waitcnt vmcnt(0)
    buffer_store_byte v0, off, s[32:35], s44 offset:32
    v_mfma_f32_16x16x32_bf16 v[118:121], a[152:155], v[46:49], v[118:121]
    s_waitcnt lgkmcnt(2)
    v_mfma_f32_16x16x32_bf16 v[110:113], a[160:163], v[50:53], v[110:113]
    ds_read_b128 v[42:45], v2 offset:28672
    v_mfma_f32_16x16x32_bf16 v[110:113], a[176:179], v[54:57], v[110:113]
    ds_read_b128 v[46:49], v2 offset:30720
    v_xor_b32 v2, 1024, v2
    v_mfma_f32_16x16x32_bf16 v[114:117], a[164:167], v[50:53], v[114:117]
    v_mfma_f32_16x16x32_bf16 v[114:117], a[180:183], v[54:57], v[114:117]
    v_mfma_f32_16x16x32_bf16 v[118:121], a[168:171], v[50:53], v[118:121]
    v_mfma_f32_16x16x32_bf16 v[118:121], a[184:187], v[54:57], v[118:121]
    s_waitcnt lgkmcnt(2)
    v_mfma_f32_16x16x32_bf16 v[110:113], a[192:195], v[34:37], v[110:113]
    ds_read_b128 v[50:53], v2 offset:0
    v_mfma_f32_16x16x32_bf16 v[110:113], a[208:211], v[38:41], v[110:113]
    ds_read_b128 v[54:57], v2 offset:2048
    v_mfma_f32_16x16x32_bf16 v[114:117], a[196:199], v[34:37], v[114:117]
    v_mfma_f32_16x16x32_bf16 v[114:117], a[212:215], v[38:41], v[114:117]
    v_mfma_f32_16x16x32_bf16 v[118:121], a[200:203], v[34:37], v[118:121]
    buffer_load_dword v123, v3, s[32:35], s47 offen offset:32 sc1
    v_mfma_f32_16x16x32_bf16 v[118:121], a[216:219], v[38:41], v[118:121]
    s_waitcnt lgkmcnt(2)
    v_mfma_f32_16x16x32_bf16 v[110:113], a[224:227], v[42:45], v[110:113]
    ds_read_b128 v[34:37], v2 offset:4096
    v_mfma_f32_16x16x32_bf16 v[110:113], a[240:243], v[46:49], v[110:113]
    ds_read_b128 v[38:41], v2 offset:6144
    v_mfma_f32_16x16x32_bf16 v[114:117], a[228:231], v[42:45], v[114:117]
    v_mfma_f32_16x16x32_bf16 v[114:117], a[244:247], v[46:49], v[114:117]
    v_mfma_f32_16x16x32_bf16 v[118:121], a[232:235], v[42:45], v[118:121]
    v_mfma_f32_16x16x32_bf16 v[118:121], a[248:251], v[46:49], v[118:121]
    s_waitcnt lgkmcnt(2)
    v_mfma_f32_16x16x32_bf16 v[94:97], a[0:3], v[50:53], 0
    ds_read_b128 v[42:45], v2 offset:8192
    v_mfma_f32_16x16x32_bf16 v[94:97], a[16:19], v[54:57], v[94:97]
    ds_read_b128 v[46:49], v2 offset:10240
    v_mfma_f32_16x16x32_bf16 v[98:101], a[4:7], v[50:53], 0
    v_exp_f32 v30, -v110
    v_mfma_f32_16x16x32_bf16 v[98:101], a[20:23], v[54:57], v[98:101]
    v_exp_f32 v31, -v111
    v_mfma_f32_16x16x32_bf16 v[102:105], a[8:11], v[50:53], 0
    v_exp_f32 v32, -v112
    v_mfma_f32_16x16x32_bf16 v[102:105], a[24:27], v[54:57], v[102:105]
    v_exp_f32 v33, -v113
    v_mfma_f32_16x16x32_bf16 v[106:109], a[12:15], v[50:53], 0
    v_add_f32 v30, 1.0, v30
    v_add_f32 v31, 1.0, v31
    v_mfma_f32_16x16x32_bf16 v[106:109], a[28:31], v[54:57], v[106:109]
    s_waitcnt lgkmcnt(2)
    v_rcp_f32 v30, v30
    v_mfma_f32_16x16x32_bf16 v[94:97], a[32:35], v[34:37], v[94:97]
    ds_read_b128 v[50:53], v2 offset:12288
    v_mul_f32 v110, v110, v30
    v_mfma_f32_16x16x32_bf16 v[94:97], a[48:51], v[38:41], v[94:97]
    ds_read_b128 v[54:57], v2 offset:14336
    v_add_f32 v32, 1.0, v32
    v_mfma_f32_16x16x32_bf16 v[98:101], a[36:39], v[34:37], v[98:101]
    v_rcp_f32 v31, v31
    v_mfma_f32_16x16x32_bf16 v[98:101], a[52:55], v[38:41], v[98:101]
    v_rcp_f32 v32, v32
    v_mfma_f32_16x16x32_bf16 v[102:105], a[40:43], v[34:37], v[102:105]
    s_waitcnt vmcnt(0)
    v_cmp_ne_u32 vcc, s46, v123
    v_mul_f32 v111, v111, v31
    v_mfma_f32_16x16x32_bf16 v[102:105], a[56:59], v[38:41], v[102:105]
    v_cvt_pk_bf16_f32 v110, v110, v111
    v_mul_f32 v112, v112, v32
    v_mfma_f32_16x16x32_bf16 v[106:109], a[44:47], v[34:37], v[106:109]
    s_cbranch_vccnz L4_wait1
L4_got1:
    buffer_load_dwordx4 v[62:65], v8, s[32:35], s88 offen sc1
    v_mfma_f32_16x16x32_bf16 v[106:109], a[60:63], v[38:41], v[106:109]
    s_waitcnt lgkmcnt(2)
    v_exp_f32 v30, -v114
    v_mfma_f32_16x16x32_bf16 v[94:97], a[64:67], v[42:45], v[94:97]
    ds_read_b128 v[34:37], v2 offset:16384
    v_add_f32 v33, 1.0, v33
    v_mfma_f32_16x16x32_bf16 v[94:97], a[80:83], v[46:49], v[94:97]
    ds_read_b128 v[38:41], v2 offset:18432
    v_add_f32 v30, 1.0, v30
    v_mfma_f32_16x16x32_bf16 v[98:101], a[68:71], v[42:45], v[98:101]
    buffer_load_dwordx4 v[66:69], v8, s[32:35], s89 offen sc1
    v_mfma_f32_16x16x32_bf16 v[98:101], a[84:87], v[46:49], v[98:101]
    v_rcp_f32 v33, v33
    v_mfma_f32_16x16x32_bf16 v[102:105], a[72:75], v[42:45], v[102:105]
    v_rcp_f32 v30, v30
    v_mfma_f32_16x16x32_bf16 v[102:105], a[88:91], v[46:49], v[102:105]
    v_exp_f32 v31, -v115
    v_mfma_f32_16x16x32_bf16 v[106:109], a[76:79], v[42:45], v[106:109]
    buffer_load_dwordx4 v[70:73], v8, s[32:35], s90 offen sc1
    v_mfma_f32_16x16x32_bf16 v[106:109], a[92:95], v[46:49], v[106:109]
    s_waitcnt lgkmcnt(2)
    v_exp_f32 v32, -v116
    v_mfma_f32_16x16x32_bf16 v[94:97], a[96:99], v[50:53], v[94:97]
    ds_read_b128 v[42:45], v2 offset:20480
    v_mul_f32 v113, v113, v33
    v_mfma_f32_16x16x32_bf16 v[94:97], a[112:115], v[54:57], v[94:97]
    ds_read_b128 v[46:49], v2 offset:22528
    v_cvt_pk_bf16_f32 v111, v112, v113
    v_mfma_f32_16x16x32_bf16 v[98:101], a[100:103], v[50:53], v[98:101]
    buffer_load_dwordx4 v[74:77], v8, s[32:35], s91 offen sc1
    v_mfma_f32_16x16x32_bf16 v[98:101], a[116:119], v[54:57], v[98:101]
    ds_write_b64 v4, v[110:111] offset:0
    v_mfma_f32_16x16x32_bf16 v[102:105], a[104:107], v[50:53], v[102:105]
    v_exp_f32 v33, -v117
    v_mfma_f32_16x16x32_bf16 v[102:105], a[120:123], v[54:57], v[102:105]
    v_mul_f32 v114, v114, v30
    v_add_f32 v31, 1.0, v31
    v_mfma_f32_16x16x32_bf16 v[106:109], a[108:111], v[50:53], v[106:109]
    buffer_load_dwordx4 v[78:81], v8, s[32:35], s92 offen sc1
    v_mfma_f32_16x16x32_bf16 v[106:109], a[124:127], v[54:57], v[106:109]
    s_waitcnt lgkmcnt(3)
    v_rcp_f32 v31, v31
    v_mfma_f32_16x16x32_bf16 v[94:97], a[128:131], v[34:37], v[94:97]
    ds_read_b128 v[50:53], v2 offset:24576
    v_mul_f32 v115, v115, v31
    v_mfma_f32_16x16x32_bf16 v[94:97], a[144:147], v[38:41], v[94:97]
    ds_read_b128 v[54:57], v2 offset:26624
    v_cvt_pk_bf16_f32 v114, v114, v115
    v_mfma_f32_16x16x32_bf16 v[98:101], a[132:135], v[34:37], v[98:101]
    buffer_load_dwordx4 v[82:85], v8, s[32:35], s93 offen sc1
    v_mfma_f32_16x16x32_bf16 v[98:101], a[148:151], v[38:41], v[98:101]
    v_exp_f32 v30, -v118
    v_mfma_f32_16x16x32_bf16 v[102:105], a[136:139], v[34:37], v[102:105]
    v_exp_f32 v31, -v119
    v_mfma_f32_16x16x32_bf16 v[102:105], a[152:155], v[38:41], v[102:105]
    v_add_f32 v32, 1.0, v32
    v_add_f32 v33, 1.0, v33
    v_mfma_f32_16x16x32_bf16 v[106:109], a[140:143], v[34:37], v[106:109]
    buffer_load_dwordx4 v[86:89], v8, s[32:35], s94 offen sc1
    v_mfma_f32_16x16x32_bf16 v[106:109], a[156:159], v[38:41], v[106:109]
    s_waitcnt lgkmcnt(3)
    v_rcp_f32 v32, v32
    v_mfma_f32_16x16x32_bf16 v[94:97], a[160:163], v[42:45], v[94:97]
    ds_read_b128 v[34:37], v2 offset:28672
    v_mul_f32 v116, v116, v32
    v_mfma_f32_16x16x32_bf16 v[94:97], a[176:179], v[46:49], v[94:97]
    ds_read_b128 v[38:41], v2 offset:30720
    v_xor_b32 v2, 1024, v2
    v_mfma_f32_16x16x32_bf16 v[98:101], a[164:167], v[42:45], v[98:101]
    buffer_load_dwordx4 v[90:93], v8, s[32:35], s95 offen sc1
    v_mfma_f32_16x16x32_bf16 v[98:101], a[180:183], v[46:49], v[98:101]
    v_rcp_f32 v33, v33
    v_mfma_f32_16x16x32_bf16 v[102:105], a[168:171], v[42:45], v[102:105]
    v_exp_f32 v32, -v120
    v_mfma_f32_16x16x32_bf16 v[102:105], a[184:187], v[46:49], v[102:105]
    v_mul_f32 v117, v117, v33
    v_cvt_pk_bf16_f32 v115, v116, v117
    v_mfma_f32_16x16x32_bf16 v[106:109], a[172:175], v[42:45], v[106:109]
    ds_write_b64 v4, v[114:115] offset:8
    v_mfma_f32_16x16x32_bf16 v[106:109], a[188:191], v[46:49], v[106:109]
    s_waitcnt lgkmcnt(3)
    v_exp_f32 v33, -v121
    v_mfma_f32_16x16x32_bf16 v[94:97], a[192:195], v[50:53], v[94:97]
    v_add_f32 v30, 1.0, v30
    v_add_f32 v31, 1.0, v31
    v_mfma_f32_16x16x32_bf16 v[94:97], a[208:211], v[54:57], v[94:97]
    v_rcp_f32 v30, v30
    v_mfma_f32_16x16x32_bf16 v[98:101], a[196:199], v[50:53], v[98:101]
    v_rcp_f32 v31, v31
    v_mfma_f32_16x16x32_bf16 v[98:101], a[212:215], v[54:57], v[98:101]
    v_mul_f32 v118, v118, v30
    v_mul_f32 v119, v119, v31
    v_mfma_f32_16x16x32_bf16 v[102:105], a[200:203], v[50:53], v[102:105]
    v_cvt_pk_bf16_f32 v118, v118, v119
    v_add_f32 v32, 1.0, v32
    v_mfma_f32_16x16x32_bf16 v[102:105], a[216:219], v[54:57], v[102:105]
    v_rcp_f32 v32, v32
    v_mfma_f32_16x16x32_bf16 v[106:109], a[204:207], v[50:53], v[106:109]
    v_mul_f32 v120, v120, v32
    v_add_f32 v33, 1.0, v33
    v_mfma_f32_16x16x32_bf16 v[106:109], a[220:223], v[54:57], v[106:109]
    s_waitcnt lgkmcnt(1)
    v_rcp_f32 v33, v33
    v_mfma_f32_16x16x32_bf16 v[94:97], a[224:227], v[34:37], v[94:97]
    v_mul_f32 v121, v121, v33
    v_cvt_pk_bf16_f32 v119, v120, v121
    v_mfma_f32_16x16x32_bf16 v[94:97], a[240:243], v[38:41], v[94:97]
    ds_write_b64 v5, v[118:119] offset:0
    v_xor_b32 v4, 1024, v4
    v_xor_b32 v5, 1024, v5
    v_mfma_f32_16x16x32_bf16 v[98:101], a[228:231], v[34:37], v[98:101]
    v_mfma_f32_16x16x32_bf16 v[98:101], a[244:247], v[38:41], v[98:101]
    v_mfma_f32_16x16x32_bf16 v[102:105], a[232:235], v[34:37], v[102:105]
    v_mfma_f32_16x16x32_bf16 v[102:105], a[248:251], v[38:41], v[102:105]
    v_mfma_f32_16x16x32_bf16 v[106:109], a[236:239], v[34:37], v[106:109]
    v_mfma_f32_16x16x32_bf16 v[106:109], a[252:255], v[38:41], v[106:109]
    v_mfma_f32_32x32x16_bf16 v[34:49], v[58:61], v[14:17], 0
    s_waitcnt vmcnt(7)
    v_exp_f32 v30, -v94
    v_exp_f32 v31, -v95
    v_exp_f32 v32, -v96
    v_mfma_f32_32x32x16_bf16 v[34:49], v[58:61], v[62:65], v[34:49]
    s_waitcnt vmcnt(6)
    v_exp_f32 v33, -v97
    v_add_f32 v30, 1.0, v30
    v_add_f32 v31, 1.0, v31
    v_rcp_f32 v30, v30
    v_mfma_f32_32x32x16_bf16 v[34:49], v[58:61], v[66:69], v[34:49]
    s_waitcnt vmcnt(5)
    v_rcp_f32 v31, v31
    v_mul_f32 v94, v94, v30
    v_mul_f32 v95, v95, v31
    v_cvt_pk_bf16_f32 v94, v94, v95
    v_add_f32 v32, 1.0, v32
    v_mfma_f32_32x32x16_bf16 v[34:49], v[58:61], v[70:73], v[34:49]
    s_waitcnt vmcnt(4)
    v_rcp_f32 v32, v32
    v_exp_f32 v30, -v98
    v_exp_f32 v31, -v99
    v_mfma_f32_32x32x16_bf16 v[34:49], v[58:61], v[74:77], v[34:49]
    s_waitcnt vmcnt(3)
    v_mul_f32 v96, v96, v32
    v_add_f32 v33, 1.0, v33
    v_rcp_f32 v33, v33
    v_exp_f32 v32, -v100
    v_mfma_f32_32x32x16_bf16 v[34:49], v[58:61], v[78:81], v[34:49]
    s_waitcnt vmcnt(2)
    v_mul_f32 v97, v97, v33
    v_cvt_pk_bf16_f32 v95, v96, v97
    v_exp_f32 v33, -v101
    v_add_f32 v30, 1.0, v30
    v_add_f32 v31, 1.0, v31
    v_mfma_f32_32x32x16_bf16 v[34:49], v[58:61], v[82:85], v[34:49]
    s_waitcnt vmcnt(1)
    ds_write_b64 v4, v[94:95] offset:0
    v_add_f32 v32, 1.0, v32
    v_rcp_f32 v30, v30
    v_mfma_f32_32x32x16_bf16 v[34:49], v[58:61], v[86:89], v[34:49]
    s_waitcnt vmcnt(0)
    buffer_store_byte v0, off, s[32:35], s44 offset:64
    v_rcp_f32 v31, v31
    v_rcp_f32 v32, v32
    v_mfma_f32_32x32x16_bf16 v[34:49], v[58:61], v[90:93], v[34:49]
    v_mul_f32 v98, v98, v30
    v_mul_f32 v99, v99, v31
    v_cvt_pk_bf16_f32 v98, v98, v99
    v_mul_f32 v100, v100, v32
    v_add_f32 v33, 1.0, v33
    v_rcp_f32 v33, v33
    s_nop 0
    v_mul_f32 v101, v101, v33
    v_cvt_pk_bf16_f32 v99, v100, v101
    ds_write_b64 v4, v[98:99] offset:8
    v_exp_f32 v30, -v102
    v_exp_f32 v31, -v103
    v_exp_f32 v32, -v104
    v_exp_f32 v33, -v105
    v_pk_add_f32 v[88:89], v[34:35], v[36:37]
    v_pk_mul_f32 v[90:91], v[34:35], v[34:35]
    v_pk_add_f32 v[88:89], v[88:89], v[38:39]
LP_3:
    s_cbranch_execz LP_back
    v_pk_fma_f32 v[90:91], v[36:37], v[36:37], v[90:91]
    v_pk_add_f32 v[88:89], v[88:89], v[40:41]
    v_pk_fma_f32 v[90:91], v[38:39], v[38:39], v[90:91]
    v_add_f32 v88, v88, v89
    v_pk_fma_f32 v[90:91], v[40:41], v[40:41], v[90:91]
    v_add_f32 v90, v90, v91
    v_lshlrev_b32 v62, 16, v22
    v_and_b32 v63, s70, v22
    v_permlane16_swap_b32 v88, v90
    v_add_f32 v88, v88, v90
    v_lshlrev_b32 v64, 16, v24
    v_and_b32 v65, s70, v24
    v_add_f32_dpp v88, v88, v88 quad_perm:[1,0,3,2] row_mask:0xf bank_mask:0xf
    v_lshlrev_b32 v66, 16, v26
    v_and_b32 v67, s70, v26
    v_add_f32_dpp v88, v88, v88 row_ror:4 row_mask:0xf bank_mask:0xf
    v_lshlrev_b32 v68, 16, v28
    v_and_b32 v69, s70, v28
    v_add_f32_dpp v88, v88, v88 row_ror:8 row_mask:0xf bank_mask:0xf
    ds_write_b32 v11, v88 offset:0
    v_pk_add_f32 v[30:31], v[30:31], 1.0 op_sel_hi:[1,0]
    v_pk_add_f32 v[32:33], v[32:33], 1.0 op_sel_hi:[1,0]
    v_rcp_f32 v30, v30
    v_rcp_f32 v31, v31
    v_rcp_f32 v32, v32
    v_rcp_f32 v33, v33
    s_waitcnt lgkmcnt(0)
    s_barrier
    ds_read2_b64 v[78:81], v12 offset0:0 offset1:2
    ds_read2_b64 v[82:85], v12 offset0:4 offset1:6
    v_pk_mul_f32 v[102:103], v[102:103], v[30:31]
    v_pk_mul_f32 v[104:105], v[104:105], v[32:33]
    v_cvt_pk_bf16_f32 v102, v102, v103
    v_cvt_pk_bf16_f32 v103, v104, v105
    ds_write_b64 v5, v[102:103] offset:0
    v_xor_b32 v4, 1024, v4
    v_xor_b32 v5, 1024, v5
    v_exp_f32 v30, -v106
    v_exp_f32 v31, -v107
    v_exp_f32 v32, -v108
    s_waitcnt lgkmcnt(1)
    v_pk_add_f32 v[78:79], v[78:79], v[80:81]
    v_pk_add_f32 v[82:83], v[82:83], v[84:85]
    v_pk_add_f32 v[78:79], v[78:79], v[82:83]
    v_mul_f32 v80, s56, v78
    v_add_f32 v79, s58, v79
    v_fma_f32 v79, -v78, v80, v79
    v_max_f32 v79, s58, v79
    v_rsq_f32 v86, v79
    v_mul_f32 v80, s60, v80
    v_mul_f32 v87, -v80, v86
    v_mul_f32 v86, s60, v86
    v_pk_fma_f32 v[70:71], v[34:35], v[86:87], v[86:87] op_sel:[0,0,1] op_sel_hi:[1,0,1]
    v_pk_fma_f32 v[72:73], v[36:37], v[86:87], v[86:87] op_sel:[0,0,1] op_sel_hi:[1,0,1]
    v_pk_fma_f32 v[74:75], v[38:39], v[86:87], v[86:87] op_sel:[0,0,1] op_sel_hi:[1,0,1]
    v_pk_fma_f32 v[76:77], v[40:41], v[86:87], v[86:87] op_sel:[0,0,1] op_sel_hi:[1,0,1]
    v_pk_fma_f32 v[34:35], v[70:71], v[62:63], v[34:35]
    v_pk_fma_f32 v[36:37], v[72:73], v[64:65], v[36:37]
    v_pk_fma_f32 v[38:39], v[74:75], v[66:67], v[38:39]
    v_pk_fma_f32 v[40:41], v[76:77], v[68:69], v[40:41]
    v_pk_add_f32 v[88:89], v[34:35], v[36:37]
    v_pk_mul_f32 v[90:91], v[34:35], v[34:35]
    v_pk_add_f32 v[88:89], v[88:89], v[38:39]
    v_pk_fma_f32 v[90:91], v[36:37], v[36:37], v[90:91]
    v_pk_add_f32 v[88:89], v[88:89], v[40:41]
    v_pk_fma_f32 v[90:91], v[38:39], v[38:39], v[90:91]
    v_add_f32 v88, v88, v89
    v_pk_fma_f32 v[90:91], v[40:41], v[40:41], v[90:91]
    v_add_f32 v90, v90, v91
    v_exp_f32 v33, -v109
    v_pk_add_f32 v[30:31], v[30:31], 1.0 op_sel_hi:[1,0]
    v_permlane16_swap_b32 v88, v90
    v_add_f32 v88, v88, v90
    v_pk_add_f32 v[32:33], v[32:33], 1.0 op_sel_hi:[1,0]
    v_rcp_f32 v30, v30
    v_add_f32_dpp v88, v88, v88 quad_perm:[1,0,3,2] row_mask:0xf bank_mask:0xf
    v_rcp_f32 v31, v31
    v_rcp_f32 v32, v32
    v_add_f32_dpp v88, v88, v88 row_ror:4 row_mask:0xf bank_mask:0xf
    v_rcp_f32 v33, v33
    v_pk_mul_f32 v[106:107], v[106:107], v[30:31]
    v_add_f32_dpp v88, v88, v88 row_ror:8 row_mask:0xf bank_mask:0xf
    ds_write_b32 v11, v88 offset:256
    ds_read_b64_tr_b16 v[110:111], v13 offset:0
    ds_read_b64_tr_b16 v[112:113], v13 offset:2048
    ds_read_b64_tr_b16 v[114:115], v127 offset:0
    ds_read_b64_tr_b16 v[116:117], v127 offset:2048
    v_pk_mul_f32 v[108:109], v[108:109], v[32:33]
    v_cvt_pk_bf16_f32 v106, v106, v107
    v_cvt_pk_bf16_f32 v107, v108, v109
    ds_write_b64 v6, v[106:107] offset:0
    s_waitcnt lgkmcnt(0)
    s_barrier
    ds_read2_b64 v[78:81], v12 offset0:32 offset1:34
    ds_read2_b64 v[82:85], v12 offset0:36 offset1:38
    buffer_load_dword v123, v3, s[32:35], s47 offen offset:64 sc1
    v_cvt_pk_bf16_f32 v14, v34, v35
    ds_read_b128 v[118:121], v1 offset:32768
    v_cvt_pk_bf16_f32 v15, v36, v37
    ds_read_b128 v[42:45], v1 offset:34816
    v_cvt_pk_bf16_f32 v16, v38, v39
    ds_read_b128 v[46:49], v1 offset:33792
    v_cvt_pk_bf16_f32 v17, v40, v41
    ds_read_b128 v[50:53], v1 offset:35840
    s_waitcnt lgkmcnt(4)
    v_pk_add_f32 v[78:79], v[78:79], v[80:81]
    v_pk_add_f32 v[82:83], v[82:83], v[84:85]
    v_pk_add_f32 v[78:79], v[78:79], v[82:83]
    v_mul_f32 v80, s56, v78
    v_add_f32 v79, s58, v79
    v_fma_f32 v79, -v78, v80, v79
    v_max_f32 v79, s58, v79
    v_rsq_f32 v86, v79
    v_mul_f32 v80, s62, v80
    v_mul_f32 v87, -v80, v86
    v_mul_f32 v86, s62, v86
    v_pk_fma_f32 v[78:79], v[34:35], v[86:87], v[86:87] op_sel:[0,0,1] op_sel_hi:[1,0,1]
    v_pk_fma_f32 v[80:81], v[36:37], v[86:87], v[86:87] op_sel:[0,0,1] op_sel_hi:[1,0,1]
    v_pk_fma_f32 v[82:83], v[38:39], v[86:87], v[86:87] op_sel:[0,0,1] op_sel_hi:[1,0,1]
    v_pk_fma_f32 v[84:85], v[40:41], v[86:87], v[86:87] op_sel:[0,0,1] op_sel_hi:[1,0,1]
    v_cvt_pk_bf16_f32 v78, v78, v79
    v_cvt_pk_bf16_f32 v79, v80, v81
    v_cvt_pk_bf16_f32 v80, v82, v83
    v_cvt_pk_bf16_f32 v81, v84, v85
    buffer_store_dwordx4 v[78:81], v9, s[32:35], s51 offen
    s_waitcnt lgkmcnt(3)
    v_mfma_f32_16x16x32_bf16 v[62:65], v[128:131], v[118:121], 0
    s_waitcnt lgkmcnt(2)
    ds_read_b128 v[54:57], v1 offset:36864
    v_mfma_f32_16x16x32_bf16 v[62:65], v[110:113], v[42:45], v[62:65]
    s_waitcnt lgkmcnt(2)
    ds_read_b64_tr_b16 v[94:95], v13 offset:4096
    ds_read_b64_tr_b16 v[96:97], v13 offset:6144
    v_mfma_f32_16x16x32_bf16 v[70:73], v[128:131], v[46:49], 0
    s_waitcnt lgkmcnt(3)
    ds_read_b128 v[98:101], v1 offset:38912
    v_mfma_f32_16x16x32_bf16 v[70:73], v[110:113], v[50:53], v[70:73]
    ds_read_b128 v[102:105], v1 offset:37888
    v_mfma_f32_16x16x32_bf16 v[74:77], v[132:135], v[46:49], 0
    ds_read_b128 v[106:109], v1 offset:39936
    v_mfma_f32_16x16x32_bf16 v[74:77], v[114:117], v[50:53], v[74:77]
    ds_read_b64_tr_b16 v[34:35], v127 offset:4096
    ds_read_b64_tr_b16 v[36:37], v127 offset:6144
    v_mfma_f32_16x16x32_bf16 v[66:69], v[132:135], v[118:121], 0
    ds_read_b128 v[38:41], v1 offset:40960
    v_mfma_f32_16x16x32_bf16 v[66:69], v[114:117], v[42:45], v[66:69]
    s_waitcnt lgkmcnt(8)
    ds_read_b64_tr_b16 v[110:111], v13 offset:8192
    ds_read_b64_tr_b16 v[112:113], v13 offset:10240
    v_mfma_f32_16x16x32_bf16 v[62:65], v[136:139], v[54:57], v[62:65]
    s_waitcnt lgkmcnt(7)
    ds_read_b128 v[46:49], v1 offset:43008
    v_mfma_f32_16x16x32_bf16 v[62:65], v[94:97], v[98:101], v[62:65]
    s_waitcnt lgkmcnt(7)
    ds_read_b128 v[118:121], v1 offset:41984
    v_mfma_f32_16x16x32_bf16 v[70:73], v[136:139], v[102:105], v[70:73]
    s_waitcnt lgkmcnt(7)
    ds_read_b128 v[114:117], v1 offset:44032
    v_mfma_f32_16x16x32_bf16 v[70:73], v[94:97], v[106:109], v[70:73]
    ds_read_b64_tr_b16 v[94:95], v127 offset:8192
    ds_read_b64_tr_b16 v[96:97], v127 offset:10240
    v_mfma_f32_16x16x32_bf16 v[74:77], v[140:143], v[102:105], v[74:77]
    s_waitcnt lgkmcnt(8)
    ds_read_b128 v[102:105], v1 offset:45056
    v_mfma_f32_16x16x32_bf16 v[74:77], v[34:37], v[106:109], v[74:77]
    v_mfma_f32_16x16x32_bf16 v[66:69], v[140:143], v[54:57], v[66:69]
    ds_read_b128 v[54:57], v1 offset:46080
    v_mfma_f32_16x16x32_bf16 v[66:69], v[34:37], v[98:101], v[66:69]
    s_waitcnt lgkmcnt(9)
    ds_read_b128 v[34:37], v1 offset:32768
    v_mfma_f32_16x16x32_bf16 v[62:65], v[144:147], v[38:41], v[62:65]
    s_waitcnt lgkmcnt(7)
    v_mfma_f32_16x16x32_bf16 v[62:65], v[110:113], v[46:49], v[62:65]
    s_waitcnt lgkmcnt(6)
    v_mfma_f32_16x16x32_bf16 v[70:73], v[144:147], v[118:121], v[70:73]
    s_waitcnt lgkmcnt(5)
    v_mfma_f32_16x16x32_bf16 v[70:73], v[110:113], v[114:117], v[70:73]
    ds_read_b64_tr_b16 v[110:111], v125 offset:0
    ds_read_b64_tr_b16 v[112:113], v125 offset:2048
    v_mfma_f32_16x16x32_bf16 v[74:77], v[148:151], v[118:121], v[74:77]
    s_waitcnt lgkmcnt(5)
    ds_read_b128 v[118:121], v1 offset:33792
    v_mfma_f32_16x16x32_bf16 v[74:77], v[94:97], v[114:117], v[74:77]
    v_mfma_f32_16x16x32_bf16 v[66:69], v[148:151], v[38:41], v[66:69]
    ds_read_b64_tr_b16 v[38:39], v122 offset:0
    ds_read_b64_tr_b16 v[40:41], v122 offset:2048
    v_mfma_f32_16x16x32_bf16 v[66:69], v[94:97], v[46:49], v[66:69]
    s_waitcnt lgkmcnt(7)
    ds_read_b128 v[94:97], v1 offset:36864
    v_mfma_f32_16x16x32_bf16 v[62:65], v[152:155], v[102:105], v[62:65]
    s_waitcnt lgkmcnt(7)
    v_mfma_f32_16x16x32_bf16 v[70:73], v[152:155], v[54:57], v[70:73]
    v_mfma_f32_16x16x32_bf16 v[74:77], v[156:159], v[54:57], v[74:77]
    ds_read_b64_tr_b16 v[54:55], v125 offset:4096
    ds_read_b64_tr_b16 v[56:57], v125 offset:6144
    v_mfma_f32_16x16x32_bf16 v[66:69], v[156:159], v[102:105], v[66:69]
    s_waitcnt lgkmcnt(8)
    ds_read_b128 v[102:105], v1 offset:37888
    v_mfma_f32_16x16x32_bf16 v[78:81], v[160:163], v[34:37], 0
    s_waitcnt lgkmcnt(7)
    v_mfma_f32_16x16x32_bf16 v[78:81], v[110:113], v[42:45], v[78:81]
    s_waitcnt lgkmcnt(6)
    v_mfma_f32_16x16x32_bf16 v[86:89], v[160:163], v[118:121], 0
    s_waitcnt vmcnt(0)
    buffer_store_byte v0, off, s[32:35], s44 offset:96
    v_mfma_f32_16x16x32_bf16 v[86:89], v[110:113], v[50:53], v[86:89]
    ds_read_b64_tr_b16 v[110:111], v122 offset:4096
    ds_read_b64_tr_b16 v[112:113], v122 offset:6144
    v_mfma_f32_16x16x32_bf16 v[90:93], v[164:167], v[118:121], 0
    s_waitcnt lgkmcnt(6)
    ds_read_b128 v[118:121], v1 offset:40960
    v_cvt_pk_bf16_f32 v70, v70, v71
    v_mfma_f32_16x16x32_bf16 v[90:93], v[38:41], v[50:53], v[90:93]
    v_cvt_pk_bf16_f32 v71, v72, v73
    v_cvt_pk_bf16_f32 v72, v74, v75
    v_mfma_f32_16x16x32_bf16 v[82:85], v[164:167], v[34:37], 0
    ds_read_b64_tr_b16 v[34:35], v125 offset:8192
    ds_read_b64_tr_b16 v[36:37], v125 offset:10240
    v_mfma_f32_16x16x32_bf16 v[82:85], v[38:41], v[42:45], v[82:85]
    s_waitcnt lgkmcnt(8)
    ds_read_b128 v[38:41], v1 offset:41984
    v_cvt_pk_bf16_f32 v73, v76, v77
    v_mfma_f32_16x16x32_bf16 v[78:81], v[168:171], v[94:97], v[78:81]
    s_waitcnt lgkmcnt(7)
    v_cmp_ne_u32 vcc, s46, v123
    v_cvt_pk_bf16_f32 v62, v62, v63
    v_mfma_f32_16x16x32_bf16 v[78:81], v[54:57], v[98:101], v[78:81]
    s_waitcnt lgkmcnt(6)
    v_cvt_pk_bf16_f32 v63, v64, v65
    v_cvt_pk_bf16_f32 v64, v66, v67
    v_mfma_f32_16x16x32_bf16 v[86:89], v[168:171], v[102:105], v[86:89]
    s_cbranch_vccnz L4_wait2
L4_got2:
    v_cvt_pk_bf16_f32 v65, v68, v69
    v_mfma_f32_16x16x32_bf16 v[86:89], v[54:57], v[106:109], v[86:89]
    ds_read_b64_tr_b16 v[54:55], v122 offset:8192
    ds_read_b64_tr_b16 v[56:57], v122 offset:10240
    v_mfma_f32_16x16x32_bf16 v[90:93], v[172:175], v[102:105], v[90:93]
    s_waitcnt lgkmcnt(6)
    buffer_store_dwordx4 v[70:73], v7, s[32:35], s53 offen offset:0
    v_mfma_f32_16x16x32_bf16 v[90:93], v[110:113], v[106:109], v[90:93]
    ds_read_b128 v[102:105], v1 offset:45056
    v_mfma_f32_16x16x32_bf16 v[82:85], v[172:175], v[94:97], v[82:85]
    ds_read_b128 v[94:97], v1 offset:46080
    v_mfma_f32_16x16x32_bf16 v[82:85], v[110:113], v[98:101], v[82:85]
    s_waitcnt lgkmcnt(7)
    ds_read_b128 v[110:113], v1 offset:32768
    v_mfma_f32_16x16x32_bf16 v[78:81], v[176:179], v[118:121], v[78:81]
    s_waitcnt lgkmcnt(6)
    v_mfma_f32_16x16x32_bf16 v[78:81], v[34:37], v[46:49], v[78:81]
    s_waitcnt lgkmcnt(5)
    v_mfma_f32_16x16x32_bf16 v[86:89], v[176:179], v[38:41], v[86:89]
    buffer_load_dword v123, v3, s[32:35], s47 offen offset:96 sc1
    v_mfma_f32_16x16x32_bf16 v[86:89], v[34:37], v[114:117], v[86:89]
    ds_read_b64_tr_b16 v[34:35], v13 offset:12288
    ds_read_b64_tr_b16 v[36:37], v13 offset:14336
    v_mfma_f32_16x16x32_bf16 v[90:93], v[180:183], v[38:41], v[90:93]
    s_waitcnt lgkmcnt(5)
    ds_read_b128 v[38:41], v1 offset:33792
    v_mfma_f32_16x16x32_bf16 v[90:93], v[54:57], v[114:117], v[90:93]
    v_mfma_f32_16x16x32_bf16 v[82:85], v[180:183], v[118:121], v[82:85]
    buffer_store_dwordx4 v[62:65], v7, s[32:35], s52 offen offset:0
    v_mfma_f32_16x16x32_bf16 v[82:85], v[54:57], v[46:49], v[82:85]
    s_waitcnt lgkmcnt(5)
    ds_read_b64_tr_b16 v[118:119], v127 offset:12288
    ds_read_b64_tr_b16 v[120:121], v127 offset:14336
    v_mfma_f32_16x16x32_bf16 v[78:81], v[184:187], v[102:105], v[78:81]
    s_waitcnt lgkmcnt(6)
    ds_read_b128 v[54:57], v1 offset:36864
    v_mfma_f32_16x16x32_bf16 v[86:89], v[184:187], v[94:97], v[86:89]
    v_mfma_f32_16x16x32_bf16 v[90:93], v[188:191], v[94:97], v[90:93]
    ds_read_b64_tr_b16 v[94:95], v13 offset:16384
    ds_read_b64_tr_b16 v[96:97], v13 offset:18432
    v_mfma_f32_16x16x32_bf16 v[82:85], v[188:191], v[102:105], v[82:85]
    s_waitcnt lgkmcnt(8)
    ds_read_b128 v[102:105], v1 offset:37888
    v_mfma_f32_16x16x32_bf16 v[62:65], v[192:195], v[110:113], 0
    s_waitcnt lgkmcnt(7)
    v_mfma_f32_16x16x32_bf16 v[62:65], v[34:37], v[42:45], v[62:65]
    s_waitcnt lgkmcnt(6)
    v_mfma_f32_16x16x32_bf16 v[70:73], v[192:195], v[38:41], 0
    v_cvt_pk_bf16_f32 v86, v86, v87
    v_cvt_pk_bf16_f32 v87, v88, v89
    v_mfma_f32_16x16x32_bf16 v[70:73], v[34:37], v[50:53], v[70:73]
    ds_read_b64_tr_b16 v[34:35], v127 offset:16384
    ds_read_b64_tr_b16 v[36:37], v127 offset:18432
    v_mfma_f32_16x16x32_bf16 v[74:77], v[196:199], v[38:41], 0
    s_waitcnt lgkmcnt(6)
    ds_read_b128 v[38:41], v1 offset:40960
    v_cvt_pk_bf16_f32 v88, v90, v91
    v_mfma_f32_16x16x32_bf16 v[74:77], v[118:121], v[50:53], v[74:77]
    v_cvt_pk_bf16_f32 v89, v92, v93
    v_cvt_pk_bf16_f32 v78, v78, v79
    v_mfma_f32_16x16x32_bf16 v[66:69], v[196:199], v[110:113], 0
    ds_read_b64_tr_b16 v[110:111], v13 offset:20480
    ds_read_b64_tr_b16 v[112:113], v13 offset:22528
    v_mfma_f32_16x16x32_bf16 v[66:69], v[118:121], v[42:45], v[66:69]
    s_waitcnt lgkmcnt(8)
    ds_read_b128 v[118:121], v1 offset:41984
    v_cvt_pk_bf16_f32 v79, v80, v81
    v_mfma_f32_16x16x32_bf16 v[62:65], v[200:203], v[54:57], v[62:65]
    s_waitcnt lgkmcnt(7)
    v_cvt_pk_bf16_f32 v80, v82, v83
    v_cvt_pk_bf16_f32 v81, v84, v85
    v_mfma_f32_16x16x32_bf16 v[62:65], v[94:97], v[98:101], v[62:65]
    s_waitcnt lgkmcnt(6)
    v_mfma_f32_16x16x32_bf16 v[70:73], v[200:203], v[102:105], v[70:73]
    v_mfma_f32_16x16x32_bf16 v[70:73], v[94:97], v[106:109], v[70:73]
    ds_read_b64_tr_b16 v[94:95], v127 offset:20480
    ds_read_b64_tr_b16 v[96:97], v127 offset:22528
    v_mfma_f32_16x16x32_bf16 v[74:77], v[204:207], v[102:105], v[74:77]
    s_waitcnt lgkmcnt(6)
    buffer_store_dwordx4 v[86:89], v7, s[32:35], s53 offen offset:256
    v_mfma_f32_16x16x32_bf16 v[74:77], v[34:37], v[106:109], v[74:77]
    ds_read_b128 v[102:105], v1 offset:45056
    v_mfma_f32_16x16x32_bf16 v[66:69], v[204:207], v[54:57], v[66:69]
    ds_read_b128 v[54:57], v1 offset:46080
    v_mfma_f32_16x16x32_bf16 v[66:69], v[34:37], v[98:101], v[66:69]
    s_waitcnt lgkmcnt(7)
    ds_read_b128 v[34:37], v1 offset:32768
    v_mfma_f32_16x16x32_bf16 v[62:65], v[208:211], v[38:41], v[62:65]
    s_waitcnt vmcnt(2) lgkmcnt(6)
    v_cmp_ne_u32 vcc, s46, v123
    v_mfma_f32_16x16x32_bf16 v[62:65], v[110:113], v[46:49], v[62:65]
    s_waitcnt lgkmcnt(5)
    v_mfma_f32_16x16x32_bf16 v[70:73], v[208:211], v[118:121], v[70:73]
    s_cbranch_vccnz L4_wait3
L4_got3:
    s_add_u32 m0, s55, 0
    s_add_u32 s76, s54, 0
    buffer_load_dwordx4 v1, s[32:35], s76 offen offset:0 sc1 lds
    v_mfma_f32_16x16x32_bf16 v[70:73], v[110:113], v[114:117], v[70:73]
    ds_read_b64_tr_b16 v[110:111], v125 offset:12288
    ds_read_b64_tr_b16 v[112:113], v125 offset:14336
    v_mfma_f32_16x16x32_bf16 v[74:77], v[212:215], v[118:121], v[74:77]
    s_waitcnt lgkmcnt(5)
    ds_read_b128 v[118:121], v1 offset:33792
    v_mfma_f32_16x16x32_bf16 v[74:77], v[94:97], v[114:117], v[74:77]
    v_mfma_f32_16x16x32_bf16 v[66:69], v[212:215], v[38:41], v[66:69]
    buffer_store_dwordx4 v[78:81], v7, s[32:35], s52 offen offset:256
    v_mfma_f32_16x16x32_bf16 v[66:69], v[94:97], v[46:49], v[66:69]
    s_waitcnt lgkmcnt(5)
    buffer_load_dwordx4 v1, s[32:35], s76 offen offset:1024 sc1 lds
    v_mfma_f32_16x16x32_bf16 v[62:65], v[216:219], v[102:105], v[62:65]
    s_waitcnt lgkmcnt(4)
    ds_read_b64_tr_b16 v[38:39], v122 offset:12288
    ds_read_b64_tr_b16 v[40:41], v122 offset:14336
    v_mfma_f32_16x16x32_bf16 v[70:73], v[216:219], v[54:57], v[70:73]
    s_add_u32 m0, s55, 8192
    ds_read_b128 v[94:97], v1 offset:36864
    v_mfma_f32_16x16x32_bf16 v[74:77], v[220:223], v[54:57], v[74:77]
    s_add_u32 s76, s54, 8192
    ds_read_b64_tr_b16 v[54:55], v125 offset:16384
    ds_read_b64_tr_b16 v[56:57], v125 offset:18432
    v_mfma_f32_16x16x32_bf16 v[66:69], v[220:223], v[102:105], v[66:69]
    s_waitcnt lgkmcnt(8)
    buffer_load_dwordx4 v1, s[32:35], s76 offen offset:0 sc1 lds
    v_mfma_f32_16x16x32_bf16 v[78:81], v[224:227], v[34:37], 0
    s_waitcnt lgkmcnt(6)
    ds_read_b128 v[102:105], v1 offset:37888
    v_mfma_f32_16x16x32_bf16 v[78:81], v[110:113], v[42:45], v[78:81]
    s_waitcnt lgkmcnt(6)
    v_mfma_f32_16x16x32_bf16 v[86:89], v[224:227], v[118:121], 0
    v_cvt_pk_bf16_f32 v70, v70, v71
    v_cvt_pk_bf16_f32 v71, v72, v73
    v_mfma_f32_16x16x32_bf16 v[86:89], v[110:113], v[50:53], v[86:89]
    buffer_load_dwordx4 v1, s[32:35], s76 offen offset:1024 sc1 lds
    v_mfma_f32_16x16x32_bf16 v[90:93], v[228:231], v[118:121], 0
    s_waitcnt lgkmcnt(4)
    ds_read_b64_tr_b16 v[110:111], v122 offset:16384
    ds_read_b64_tr_b16 v[112:113], v122 offset:18432
    v_mfma_f32_16x16x32_bf16 v[90:93], v[38:41], v[50:53], v[90:93]
    s_add_u32 m0, s55, 16384
    ds_read_b128 v[118:121], v1 offset:40960
    v_cvt_pk_bf16_f32 v72, v74, v75
    v_mfma_f32_16x16x32_bf16 v[82:85], v[228:231], v[34:37], 0
    s_add_u32 s76, s54, 16384
    ds_read_b64_tr_b16 v[50:51], v125 offset:20480
    ds_read_b64_tr_b16 v[52:53], v125 offset:22528
    v_mfma_f32_16x16x32_bf16 v[82:85], v[38:41], v[42:45], v[82:85]
    s_waitcnt lgkmcnt(8)
    buffer_load_dwordx4 v1, s[32:35], s76 offen offset:0 sc1 lds
    v_mfma_f32_16x16x32_bf16 v[78:81], v[232:235], v[94:97], v[78:81]
    s_waitcnt lgkmcnt(6)
    ds_read_b128 v[34:37], v1 offset:41984
    v_cvt_pk_bf16_f32 v73, v76, v77
    v_mfma_f32_16x16x32_bf16 v[78:81], v[54:57], v[98:101], v[78:81]
    s_waitcnt lgkmcnt(6)
    ds_read_b64_tr_b16 v[38:39], v122 offset:20480
    ds_read_b64_tr_b16 v[40:41], v122 offset:22528
    v_mfma_f32_16x16x32_bf16 v[86:89], v[232:235], v[102:105], v[86:89]
    ds_read_b128 v[42:45], v1 offset:45056
    v_cvt_pk_bf16_f32 v62, v62, v63
    v_mfma_f32_16x16x32_bf16 v[86:89], v[54:57], v[106:109], v[86:89]
    buffer_load_dwordx4 v1, s[32:35], s76 offen offset:1024 sc1 lds
    v_mfma_f32_16x16x32_bf16 v[90:93], v[236:239], v[102:105], v[90:93]
    s_waitcnt lgkmcnt(7)
    buffer_store_dwordx4 v[70:73], v7, s[32:35], s53 offen offset:512
    v_mfma_f32_16x16x32_bf16 v[90:93], v[110:113], v[106:109], v[90:93]
    s_add_u32 m0, s55, 24576
    ds_read_b128 v[54:57], v1 offset:46080
    v_cvt_pk_bf16_f32 v63, v64, v65
    v_mfma_f32_16x16x32_bf16 v[82:85], v[236:239], v[94:97], v[82:85]
    s_add_u32 s76, s54, 24576
    v_cvt_pk_bf16_f32 v64, v66, v67
    v_cvt_pk_bf16_f32 v65, v68, v69
    v_mfma_f32_16x16x32_bf16 v[82:85], v[110:113], v[98:101], v[82:85]
    s_waitcnt lgkmcnt(7)
    buffer_load_dwordx4 v1, s[32:35], s76 offen offset:0 sc1 lds
    v_mfma_f32_16x16x32_bf16 v[78:81], v[240:243], v[118:121], v[78:81]
    s_waitcnt lgkmcnt(5)
    v_mfma_f32_16x16x32_bf16 v[78:81], v[50:53], v[46:49], v[78:81]
    s_waitcnt lgkmcnt(4)
    v_mfma_f32_16x16x32_bf16 v[86:89], v[240:243], v[34:37], v[86:89]
    v_mfma_f32_16x16x32_bf16 v[86:89], v[50:53], v[114:117], v[86:89]
    buffer_load_dwordx4 v1, s[32:35], s76 offen offset:1024 sc1 lds
    v_mfma_f32_16x16x32_bf16 v[90:93], v[244:247], v[34:37], v[90:93]
    s_waitcnt lgkmcnt(2)
    v_mfma_f32_16x16x32_bf16 v[90:93], v[38:41], v[114:117], v[90:93]
    v_mfma_f32_16x16x32_bf16 v[82:85], v[244:247], v[118:121], v[82:85]
    buffer_store_dwordx4 v[62:65], v7, s[32:35], s52 offen offset:512
    v_mfma_f32_16x16x32_bf16 v[82:85], v[38:41], v[46:49], v[82:85]
    s_waitcnt lgkmcnt(1)
    v_mfma_f32_16x16x32_bf16 v[78:81], v[248:251], v[42:45], v[78:81]
    s_waitcnt lgkmcnt(0)
    v_mfma_f32_16x16x32_bf16 v[86:89], v[248:251], v[54:57], v[86:89]
    v_mfma_f32_16x16x32_bf16 v[90:93], v[252:255], v[54:57], v[90:93]
    v_mfma_f32_16x16x32_bf16 v[82:85], v[252:255], v[42:45], v[82:85]
    s_waitcnt vmcnt(8)
    s_barrier
    ds_read_b128 v[34:37], v2 offset:0
    ds_read_b128 v[38:41], v2 offset:2048
    ds_read_b128 v[42:45], v2 offset:4096
    ds_read_b128 v[46:49], v2 offset:6144
    v_cvt_pk_bf16_f32 v86, v86, v87
    v_cvt_pk_bf16_f32 v87, v88, v89
    v_cvt_pk_bf16_f32 v88, v90, v91
    v_cvt_pk_bf16_f32 v89, v92, v93
    buffer_store_dwordx4 v[86:89], v124, s[32:35], s26 offen
    v_cvt_pk_bf16_f32 v78, v78, v79
    v_cvt_pk_bf16_f32 v79, v80, v81
    v_cvt_pk_bf16_f32 v80, v82, v83
    v_cvt_pk_bf16_f32 v81, v84, v85
    buffer_store_dwordx4 v[78:81], v124, s[32:35], s81 offen
    s_waitcnt lgkmcnt(2)
    v_mfma_f32_16x16x32_bf16 v[110:113], a[0:3], v[34:37], 0
    s_waitcnt vmcnt(8)
    s_barrier
    ds_read_b128 v[50:53], v2 offset:8192
    v_mfma_f32_16x16x32_bf16 v[110:113], a[16:19], v[38:41], v[110:113]
    ds_read_b128 v[54:57], v2 offset:10240
    v_mfma_f32_16x16x32_bf16 v[114:117], a[4:7], v[34:37], 0
    v_mfma_f32_16x16x32_bf16 v[114:117], a[20:23], v[38:41], v[114:117]
    v_mfma_f32_16x16x32_bf16 v[118:121], a[8:11], v[34:37], 0
    v_mfma_f32_16x16x32_bf16 v[118:121], a[24:27], v[38:41], v[118:121]
    s_waitcnt lgkmcnt(2)
    v_mfma_f32_16x16x32_bf16 v[110:113], a[32:35], v[42:45], v[110:113]
    ds_read_b128 v[34:37], v2 offset:12288
    v_mfma_f32_16x16x32_bf16 v[110:113], a[48:51], v[46:49], v[110:113]
    ds_read_b128 v[38:41], v2 offset:14336
    v_mfma_f32_16x16x32_bf16 v[114:117], a[36:39], v[42:45], v[114:117]
    v_mfma_f32_16x16x32_bf16 v[114:117], a[52:55], v[46:49], v[114:117]
    v_mfma_f32_16x16x32_bf16 v[118:121], a[40:43], v[42:45], v[118:121]
    v_mfma_f32_16x16x32_bf16 v[118:121], a[56:59], v[46:49], v[118:121]
    s_waitcnt lgkmcnt(2)
    v_mfma_f32_16x16x32_bf16 v[110:113], a[64:67], v[50:53], v[110:113]
    s_waitcnt vmcnt(6)
    s_barrier
    ds_read_b128 v[42:45], v2 offset:16384
    v_mfma_f32_16x16x32_bf16 v[110:113], a[80:83], v[54:57], v[110:113]
    ds_read_b128 v[46:49], v2 offset:18432
    v_mfma_f32_16x16x32_bf16 v[114:117], a[68:71], v[50:53], v[114:117]
    v_mfma_f32_16x16x32_bf16 v[114:117], a[84:87], v[54:57], v[114:117]
    v_mfma_f32_16x16x32_bf16 v[118:121], a[72:75], v[50:53], v[118:121]
    v_mfma_f32_16x16x32_bf16 v[118:121], a[88:91], v[54:57], v[118:121]
    s_waitcnt lgkmcnt(2)
    v_mfma_f32_16x16x32_bf16 v[110:113], a[96:99], v[34:37], v[110:113]
    ds_read_b128 v[50:53], v2 offset:20480
    v_mfma_f32_16x16x32_bf16 v[110:113], a[112:115], v[38:41], v[110:113]
    ds_read_b128 v[54:57], v2 offset:22528
    v_mfma_f32_16x16x32_bf16 v[114:117], a[100:103], v[34:37], v[114:117]
    v_mfma_f32_16x16x32_bf16 v[114:117], a[116:119], v[38:41], v[114:117]
    v_mfma_f32_16x16x32_bf16 v[118:121], a[104:107], v[34:37], v[118:121]
    v_mfma_f32_16x16x32_bf16 v[118:121], a[120:123], v[38:41], v[118:121]
    s_waitcnt lgkmcnt(2)
    v_mfma_f32_16x16x32_bf16 v[110:113], a[128:131], v[42:45], v[110:113]
    s_waitcnt vmcnt(3)
    s_barrier
    ds_read_b128 v[34:37], v2 offset:24576
    v_mfma_f32_16x16x32_bf16 v[110:113], a[144:147], v[46:49], v[110:113]
    ds_read_b128 v[38:41], v2 offset:26624
    v_mfma_f32_16x16x32_bf16 v[114:117], a[132:135], v[42:45], v[114:117]
    v_mfma_f32_16x16x32_bf16 v[114:117], a[148:151], v[46:49], v[114:117]
    v_mfma_f32_16x16x32_bf16 v[118:121], a[136:139], v[42:45], v[118:121]
    s_waitcnt vmcnt(0)
    buffer_store_byte v0, off, s[32:35], s44 offset:128
    v_mfma_f32_16x16x32_bf16 v[118:121], a[152:155], v[46:49], v[118:121]
    s_waitcnt lgkmcnt(2)
    v_mfma_f32_16x16x32_bf16 v[110:113], a[160:163], v[50:53], v[110:113]
    ds_read_b128 v[42:45], v2 offset:28672
    v_mfma_f32_16x16x32_bf16 v[110:113], a[176:179], v[54:57], v[110:113]
    ds_read_b128 v[46:49], v2 offset:30720
    v_xor_b32 v2, 1024, v2
    v_mfma_f32_16x16x32_bf16 v[114:117], a[164:167], v[50:53], v[114:117]
    v_mfma_f32_16x16x32_bf16 v[114:117], a[180:183], v[54:57], v[114:117]
    v_mfma_f32_16x16x32_bf16 v[118:121], a[168:171], v[50:53], v[118:121]
    v_mfma_f32_16x16x32_bf16 v[118:121], a[184:187], v[54:57], v[118:121]
    s_waitcnt lgkmcnt(2)
    v_mfma_f32_16x16x32_bf16 v[110:113], a[192:195], v[34:37], v[110:113]
    ds_read_b128 v[50:53], v2 offset:0
    v_mfma_f32_16x16x32_bf16 v[110:113], a[208:211], v[38:41], v[110:113]
    ds_read_b128 v[54:57], v2 offset:2048
    v_mfma_f32_16x16x32_bf16 v[114:117], a[196:199], v[34:37], v[114:117]
    v_mfma_f32_16x16x32_bf16 v[114:117], a[212:215], v[38:41], v[114:117]
    v_mfma_f32_16x16x32_bf16 v[118:121], a[200:203], v[34:37], v[118:121]
    v_mfma_f32_16x16x32_bf16 v[118:121], a[216:219], v[38:41], v[118:121]
    s_waitcnt lgkmcnt(2)
    v_mfma_f32_16x16x32_bf16 v[110:113], a[224:227], v[42:45], v[110:113]
    ds_read_b128 v[34:37], v2 offset:4096
    v_mfma_f32_16x16x32_bf16 v[110:113], a[240:243], v[46:49], v[110:113]
    ds_read_b128 v[38:41], v2 offset:6144
    v_mfma_f32_16x16x32_bf16 v[114:117], a[228:231], v[42:45], v[114:117]
    v_mfma_f32_16x16x32_bf16 v[114:117], a[244:247], v[46:49], v[114:117]
    buffer_load_dword v123, v3, s[32:35], s47 offen offset:128 sc1
    v_mfma_f32_16x16x32_bf16 v[118:121], a[232:235], v[42:45], v[118:121]
    v_mfma_f32_16x16x32_bf16 v[118:121], a[248:251], v[46:49], v[118:121]
    s_waitcnt lgkmcnt(2)
    v_mfma_f32_16x16x32_bf16 v[94:97], a[0:3], v[50:53], 0
    ds_read_b128 v[42:45], v2 offset:8192
    v_mfma_f32_16x16x32_bf16 v[94:97], a[16:19], v[54:57], v[94:97]
    ds_read_b128 v[46:49], v2 offset:10240
    v_mfma_f32_16x16x32_bf16 v[98:101], a[4:7], v[50:53], 0
    v_exp_f32 v30, -v110
    v_mfma_f32_16x16x32_bf16 v[98:101], a[20:23], v[54:57], v[98:101]
    v_exp_f32 v31, -v111
    v_mfma_f32_16x16x32_bf16 v[102:105], a[8:11], v[50:53], 0
    v_exp_f32 v32, -v112
    v_mfma_f32_16x16x32_bf16 v[102:105], a[24:27], v[54:57], v[102:105]
    v_exp_f32 v33, -v113
    v_mfma_f32_16x16x32_bf16 v[106:109], a[12:15], v[50:53], 0
    v_add_f32 v30, 1.0, v30
    v_add_f32 v31, 1.0, v31
    v_mfma_f32_16x16x32_bf16 v[106:109], a[28:31], v[54:57], v[106:109]
    s_waitcnt lgkmcnt(2)
    v_rcp_f32 v30, v30
    v_mfma_f32_16x16x32_bf16 v[94:97], a[32:35], v[34:37], v[94:97]
    ds_read_b128 v[50:53], v2 offset:12288
    v_mul_f32 v110, v110, v30
    v_mfma_f32_16x16x32_bf16 v[94:97], a[48:51], v[38:41], v[94:97]
    ds_read_b128 v[54:57], v2 offset:14336
    v_add_f32 v32, 1.0, v32
    v_mfma_f32_16x16x32_bf16 v[98:101], a[36:39], v[34:37], v[98:101]
    v_rcp_f32 v31, v31
    v_mfma_f32_16x16x32_bf16 v[98:101], a[52:55], v[38:41], v[98:101]
    v_rcp_f32 v32, v32
    v_mfma_f32_16x16x32_bf16 v[102:105], a[40:43], v[34:37], v[102:105]
    v_exp_f32 v30, -v114
    v_mfma_f32_16x16x32_bf16 v[102:105], a[56:59], v[38:41], v[102:105]
    v_mul_f32 v111, v111, v31
    v_cvt_pk_bf16_f32 v110, v110, v111
    v_mfma_f32_16x16x32_bf16 v[106:109], a[44:47], v[34:37], v[106:109]
    v_exp_f32 v31, -v115
    v_mfma_f32_16x16x32_bf16 v[106:109], a[60:63], v[38:41], v[106:109]
    s_waitcnt lgkmcnt(2)
    v_mul_f32 v112, v112, v32
    v_add_f32 v33, 1.0, v33
    v_mfma_f32_16x16x32_bf16 v[94:97], a[64:67], v[42:45], v[94:97]
    ds_read_b128 v[34:37], v2 offset:16384
    v_add_f32 v30, 1.0, v30
    v_mfma_f32_16x16x32_bf16 v[94:97], a[80:83], v[46:49], v[94:97]
    ds_read_b128 v[38:41], v2 offset:18432
    v_add_f32 v31, 1.0, v31
    v_mfma_f32_16x16x32_bf16 v[98:101], a[68:71], v[42:45], v[98:101]
    v_rcp_f32 v33, v33
    v_mfma_f32_16x16x32_bf16 v[98:101], a[84:87], v[46:49], v[98:101]
    v_rcp_f32 v30, v30
    v_mfma_f32_16x16x32_bf16 v[102:105], a[72:75], v[42:45], v[102:105]
    s_waitcnt vmcnt(0)
    v_cmp_ne_u32 vcc, s46, v123
    v_mul_f32 v113, v113, v33
    v_mfma_f32_16x16x32_bf16 v[102:105], a[88:91], v[46:49], v[102:105]
    v_cvt_pk_bf16_f32 v111, v112, v113
    v_mul_f32 v114, v114, v30
    v_mfma_f32_16x16x32_bf16 v[106:109], a[76:79], v[42:45], v[106:109]
    s_cbranch_vccnz L4_wait4
L4_got4:
    buffer_load_dwordx4 v[62:65], v8, s[32:35], s88 offen sc1
    v_mfma_f32_16x16x32_bf16 v[106:109], a[92:95], v[46:49], v[106:109]
LP_4:
    s_cbranch_execz LP_5
    s_waitcnt lgkmcnt(2)
    ds_write_b64 v4, v[110:111] offset:0
    v_mfma_f32_16x16x32_bf16 v[94:97], a[96:99], v[50:53], v[94:97]
    ds_read_b128 v[42:45], v2 offset:20480
    v_mfma_f32_16x16x32_bf16 v[94:97], a[112:115], v[54:57], v[94:97]
    ds_read_b128 v[46:49], v2 offset:22528
    v_mfma_f32_16x16x32_bf16 v[98:101], a[100:103], v[50:53], v[98:101]
    buffer_load_dwordx4 v[66:69], v8, s[32:35], s89 offen sc1
    v_mfma_f32_16x16x32_bf16 v[98:101], a[116:119], v[54:57], v[98:101]
    v_rcp_f32 v31, v31
    v_mfma_f32_16x16x32_bf16 v[102:105], a[104:107], v[50:53], v[102:105]
    v_exp_f32 v32, -v116
    v_mfma_f32_16x16x32_bf16 v[102:105], a[120:123], v[54:57], v[102:105]
    v_exp_f32 v33, -v117
    v_mfma_f32_16x16x32_bf16 v[106:109], a[108:111], v[50:53], v[106:109]
    buffer_load_dwordx4 v[70:73], v8, s[32:35], s90 offen sc1
    v_mfma_f32_16x16x32_bf16 v[106:109], a[124:127], v[54:57], v[106:109]
    s_waitcnt lgkmcnt(3)
    v_exp_f32 v30, -v118
    v_mfma_f32_16x16x32_bf16 v[94:97], a[128:131], v[34:37], v[94:97]
    ds_read_b128 v[50:53], v2 offset:24576
    v_mul_f32 v115, v115, v31
    v_mfma_f32_16x16x32_bf16 v[94:97], a[144:147], v[38:41], v[94:97]
    ds_read_b128 v[54:57], v2 offset:26624
    v_cvt_pk_bf16_f32 v114, v114, v115
    v_mfma_f32_16x16x32_bf16 v[98:101], a[132:135], v[34:37], v[98:101]
    buffer_load_dwordx4 v[74:77], v8, s[32:35], s91 offen sc1
    v_mfma_f32_16x16x32_bf16 v[98:101], a[148:151], v[38:41], v[98:101]
    v_exp_f32 v31, -v119
    v_mfma_f32_16x16x32_bf16 v[102:105], a[136:139], v[34:37], v[102:105]
    v_add_f32 v32, 1.0, v32
    v_add_f32 v33, 1.0, v33
    v_mfma_f32_16x16x32_bf16 v[102:105], a[152:155], v[38:41], v[102:105]
    v_rcp_f32 v32, v32
    v_mfma_f32_16x16x32_bf16 v[106:109], a[140:143], v[34:37], v[106:109]
    buffer_load_dwordx4 v[78:81], v8, s[32:35], s92 offen sc1
    v_mfma_f32_16x16x32_bf16 v[106:109], a[156:159], v[38:41], v[106:109]
    s_waitcnt lgkmcnt(2)
    v_rcp_f32 v33, v33
    v_mfma_f32_16x16x32_bf16 v[94:97], a[160:163], v[42:45], v[94:97]
    ds_read_b128 v[34:37], v2 offset:28672
    v_mul_f32 v116, v116, v32
    v_mfma_f32_16x16x32_bf16 v[94:97], a[176:179], v[46:49], v[94:97]
    ds_read_b128 v[38:41], v2 offset:30720
    v_xor_b32 v2, 1024, v2
    v_mfma_f32_16x16x32_bf16 v[98:101], a[164:167], v[42:45], v[98:101]
    buffer_load_dwordx4 v[82:85], v8, s[32:35], s93 offen sc1
    v_mfma_f32_16x16x32_bf16 v[98:101], a[180:183], v[46:49], v[98:101]
    v_exp_f32 v32, -v120
    v_mfma_f32_16x16x32_bf16 v[102:105], a[168:171], v[42:45], v[102:105]
    v_mul_f32 v117, v117, v33
    v_cvt_pk_bf16_f32 v115, v116, v117
    v_mfma_f32_16x16x32_bf16 v[102:105], a[184:187], v[46:49], v[102:105]
    ds_write_b64 v4, v[114:115] offset:8
    v_mfma_f32_16x16x32_bf16 v[106:109], a[172:175], v[42:45], v[106:109]
    buffer_load_dwordx4 v[86:89], v8, s[32:35], s94 offen sc1
    v_mfma_f32_16x16x32_bf16 v[106:109], a[188:191], v[46:49], v[106:109]
    s_waitcnt lgkmcnt(3)
    v_exp_f32 v33, -v121
    v_mfma_f32_16x16x32_bf16 v[94:97], a[192:195], v[50:53], v[94:97]
    v_add_f32 v30, 1.0, v30
    v_add_f32 v31, 1.0, v31
    v_mfma_f32_16x16x32_bf16 v[94:97], a[208:211], v[54:57], v[94:97]
    v_rcp_f32 v30, v30
    v_mfma_f32_16x16x32_bf16 v[98:101], a[196:199], v[50:53], v[98:101]
    buffer_load_dwordx4 v[90:93], v8, s[32:35], s95 offen sc1
    v_mfma_f32_16x16x32_bf16 v[98:101], a[212:215], v[54:57], v[98:101]
    v_rcp_f32 v31, v31
    v_mfma_f32_16x16x32_bf16 v[102:105], a[200:203], v[50:53], v[102:105]
    v_mul_f32 v118, v118, v30
    v_mul_f32 v119, v119, v31
    v_mfma_f32_16x16x32_bf16 v[102:105], a[216:219], v[54:57], v[102:105]
    v_cvt_pk_bf16_f32 v118, v118, v119
    v_add_f32 v32, 1.0, v32
    v_mfma_f32_16x16x32_bf16 v[106:109], a[204:207], v[50:53], v[106:109]
    v_rcp_f32 v32, v32
    v_mfma_f32_16x16x32_bf16 v[106:109], a[220:223], v[54:57], v[106:109]
    s_waitcnt lgkmcnt(1)
    v_mul_f32 v120, v120, v32
    v_add_f32 v33, 1.0, v33
    v_mfma_f32_16x16x32_bf16 v[94:97], a[224:227], v[34:37], v[94:97]
    v_rcp_f32 v33, v33
    v_mfma_f32_16x16x32_bf16 v[94:97], a[240:243], v[38:41], v[94:97]
    v_mul_f32 v121, v121, v33
    v_cvt_pk_bf16_f32 v119, v120, v121
    v_mfma_f32_16x16x32_bf16 v[98:101], a[228:231], v[34:37], v[98:101]
    ds_write_b64 v5, v[118:119] offset:0
    v_xor_b32 v4, 1024, v4
    v_xor_b32 v5, 1024, v5
    v_mfma_f32_16x16x32_bf16 v[98:101], a[244:247], v[38:41], v[98:101]
    v_mfma_f32_16x16x32_bf16 v[102:105], a[232:235], v[34:37], v[102:105]
    v_mfma_f32_16x16x32_bf16 v[102:105], a[248:251], v[38:41], v[102:105]
    v_mfma_f32_16x16x32_bf16 v[106:109], a[236:239], v[34:37], v[106:109]
    v_mfma_f32_16x16x32_bf16 v[106:109], a[252:255], v[38:41], v[106:109]
    v_mfma_f32_32x32x16_bf16 v[34:49], v[58:61], v[18:21], 0
    s_waitcnt vmcnt(7)
    v_exp_f32 v30, -v94
    v_exp_f32 v31, -v95
    v_exp_f32 v32, -v96
    v_mfma_f32_32x32x16_bf16 v[34:49], v[58:61], v[62:65], v[34:49]
    s_waitcnt vmcnt(6)
    v_exp_f32 v33, -v97
    v_add_f32 v30, 1.0, v30
    v_add_f32 v31, 1.0, v31
    v_rcp_f32 v30, v30
    v_mfma_f32_32x32x16_bf16 v[34:49], v[58:61], v[66:69], v[34:49]
    s_waitcnt vmcnt(5)
    v_rcp_f32 v31, v31
    v_mul_f32 v94, v94, v30
    v_mul_f32 v95, v95, v31
    v_cvt_pk_bf16_f32 v94, v94, v95
    v_add_f32 v32, 1.0, v32
    v_mfma_f32_32x32x16_bf16 v[34:49], v[58:61], v[70:73], v[34:49]
    s_waitcnt vmcnt(4)
    v_rcp_f32 v32, v32
    v_exp_f32 v30, -v98
    v_exp_f32 v31, -v99
    v_mfma_f32_32x32x16_bf16 v[34:49], v[58:61], v[74:77], v[34:49]
    s_waitcnt vmcnt(3)
    v_mul_f32 v96, v96, v32
    v_add_f32 v33, 1.0, v33
    v_rcp_f32 v33, v33
    v_exp_f32 v32, -v100
    v_mfma_f32_32x32x16_bf16 v[34:49], v[58:61], v[78:81], v[34:49]
    s_waitcnt vmcnt(2)
    v_mul_f32 v97, v97, v33
    v_cvt_pk_bf16_f32 v95, v96, v97
    v_exp_f32 v33, -v101
    v_add_f32 v30, 1.0, v30
    v_add_f32 v31, 1.0, v31
    v_mfma_f32_32x32x16_bf16 v[34:49], v[58:61], v[82:85], v[34:49]
    s_waitcnt vmcnt(1)
    ds_write_b64 v4, v[94:95] offset:0
    v_add_f32 v32, 1.0, v32
    v_rcp_f32 v30, v30
    v_mfma_f32_32x32x16_bf16 v[34:49], v[58:61], v[86:89], v[34:49]
    s_waitcnt vmcnt(0)
    buffer_store_byte v0, off, s[32:35], s44 offset:160
    v_rcp_f32 v31, v31
    v_rcp_f32 v32, v32
    v_mfma_f32_32x32x16_bf16 v[34:49], v[58:61], v[90:93], v[34:49]
    v_mul_f32 v98, v98, v30
    v_mul_f32 v99, v99, v31
    v_cvt_pk_bf16_f32 v98, v98, v99
    v_mul_f32 v100, v100, v32
    v_add_f32 v33, 1.0, v33
    v_rcp_f32 v33, v33
    s_nop 0
    v_mul_f32 v101, v101, v33
    v_cvt_pk_bf16_f32 v99, v100, v101
    ds_write_b64 v4, v[98:99] offset:8
    v_exp_f32 v30, -v102
    v_exp_f32 v31, -v103
    v_exp_f32 v32, -v104
    v_exp_f32 v33, -v105
    v_pk_add_f32 v[88:89], v[34:35], v[36:37]
    v_pk_mul_f32 v[90:91], v[34:35], v[34:35]
    v_pk_add_f32 v[88:89], v[88:89], v[38:39]
    v_pk_fma_f32 v[90:91], v[36:37], v[36:37], v[90:91]
    v_pk_add_f32 v[88:89], v[88:89], v[40:41]
    v_pk_fma_f32 v[90:91], v[38:39], v[38:39], v[90:91]
    v_add_f32 v88, v88, v89
    v_pk_fma_f32 v[90:91], v[40:41], v[40:41], v[90:91]
    v_add_f32 v90, v90, v91
    v_lshlrev_b32 v62, 16, v23
    v_and_b32 v63, s70, v23
    v_permlane16_swap_b32 v88, v90
    v_add_f32 v88, v88, v90
    v_lshlrev_b32 v64, 16, v25
    v_and_b32 v65, s70, v25
    v_add_f32_dpp v88, v88, v88 quad_perm:[1,0,3,2] row_mask:0xf bank_mask:0xf
    v_lshlrev_b32 v66, 16, v27
    v_and_b32 v67, s70, v27
    v_add_f32_dpp v88, v88, v88 row_ror:4 row_mask:0xf bank_mask:0xf
    v_lshlrev_b32 v68, 16, v29
    v_and_b32 v69, s70, v29
    v_add_f32_dpp v88, v88, v88 row_ror:8 row_mask:0xf bank_mask:0xf
    ds_write_b32 v11, v88 offset:0
    v_pk_add_f32 v[30:31], v[30:31], 1.0 op_sel_hi:[1,0]
    v_pk_add_f32 v[32:33], v[32:33], 1.0 op_sel_hi:[1,0]
    v_rcp_f32 v30, v30
    v_rcp_f32 v31, v31
    v_rcp_f32 v32, v32
    v_rcp_f32 v33, v33
    s_waitcnt lgkmcnt(0)
    s_barrier
    ds_read2_b64 v[78:81], v12 offset0:0 offset1:2
    ds_read2_b64 v[82:85], v12 offset0:4 offset1:6
    v_pk_mul_f32 v[102:103], v[102:103], v[30:31]
    v_pk_mul_f32 v[104:105], v[104:105], v[32:33]
    v_cvt_pk_bf16_f32 v102, v102, v103
    v_cvt_pk_bf16_f32 v103, v104, v105
    ds_write_b64 v5, v[102:103] offset:0
    v_xor_b32 v4, 1024, v4
    v_xor_b32 v5, 1024, v5
    v_exp_f32 v30, -v106
    v_exp_f32 v31, -v107
    v_exp_f32 v32, -v108
    s_waitcnt lgkmcnt(1)
    v_pk_add_f32 v[78:79], v[78:79], v[80:81]
    v_pk_add_f32 v[82:83], v[82:83], v[84:85]
    v_pk_add_f32 v[78:79], v[78:79], v[82:83]
    v_mul_f32 v80, s56, v78
    v_add_f32 v79, s58, v79
    v_fma_f32 v79, -v78, v80, v79
    v_max_f32 v79, s58, v79
    v_rsq_f32 v86, v79
    v_mul_f32 v80, s60, v80
    v_mul_f32 v87, -v80, v86
    v_mul_f32 v86, s60, v86
    v_pk_fma_f32 v[70:71], v[34:35], v[86:87], v[86:87] op_sel:[0,0,1] op_sel_hi:[1,0,1]
    v_pk_fma_f32 v[72:73], v[36:37], v[86:87], v[86:87] op_sel:[0,0,1] op_sel_hi:[1,0,1]
    v_pk_fma_f32 v[74:75], v[38:39], v[86:87], v[86:87] op_sel:[0,0,1] op_sel_hi:[1,0,1]
    v_pk_fma_f32 v[76:77], v[40:41], v[86:87], v[86:87] op_sel:[0,0,1] op_sel_hi:[1,0,1]
    v_pk_fma_f32 v[34:35], v[70:71], v[62:63], v[34:35]
    v_pk_fma_f32 v[36:37], v[72:73], v[64:65], v[36:37]
    v_pk_fma_f32 v[38:39], v[74:75], v[66:67], v[38:39]
    v_pk_fma_f32 v[40:41], v[76:77], v[68:69], v[40:41]
    v_pk_add_f32 v[88:89], v[34:35], v[36:37]
    v_pk_mul_f32 v[90:91], v[34:35], v[34:35]
    v_pk_add_f32 v[88:89], v[88:89], v[38:39]
    v_pk_fma_f32 v[90:91], v[36:37], v[36:37], v[90:91]
    v_pk_add_f32 v[88:89], v[88:89], v[40:41]
    v_pk_fma_f32 v[90:91], v[38:39], v[38:39], v[90:91]
    v_add_f32 v88, v88, v89
    v_pk_fma_f32 v[90:91], v[40:41], v[40:41], v[90:91]
    v_add_f32 v90, v90, v91
    v_exp_f32 v33, -v109
    v_pk_add_f32 v[30:31], v[30:31], 1.0 op_sel_hi:[1,0]
    v_permlane16_swap_b32 v88, v90
    v_add_f32 v88, v88, v90
    v_pk_add_f32 v[32:33], v[32:33], 1.0 op_sel_hi:[1,0]
    v_rcp_f32 v30, v30
    v_add_f32_dpp v88, v88, v88 quad_perm:[1,0,3,2] row_mask:0xf bank_mask:0xf
    v_rcp_f32 v31, v31
    v_rcp_f32 v32, v32
    v_add_f32_dpp v88, v88, v88 row_ror:4 row_mask:0xf bank_mask:0xf
    v_rcp_f32 v33, v33
    v_pk_mul_f32 v[106:107], v[106:107], v[30:31]
    v_add_f32_dpp v88, v88, v88 row_ror:8 row_mask:0xf bank_mask:0xf
    ds_write_b32 v11, v88 offset:256
    ds_read_b64_tr_b16 v[110:111], v13 offset:0
    ds_read_b64_tr_b16 v[112:113], v13 offset:2048
    ds_read_b64_tr_b16 v[114:115], v127 offset:0
    ds_read_b64_tr_b16 v[116:117], v127 offset:2048
    v_pk_mul_f32 v[108:109], v[108:109], v[32:33]
    v_cvt_pk_bf16_f32 v106, v106, v107
    v_cvt_pk_bf16_f32 v107, v108, v109
    ds_write_b64 v6, v[106:107] offset:0
    s_waitcnt lgkmcnt(0)
    s_barrier
    ds_read2_b64 v[78:81], v12 offset0:32 offset1:34
    ds_read2_b64 v[82:85], v12 offset0:36 offset1:38
    buffer_load_dword v123, v3, s[32:35], s47 offen offset:160 sc1
    v_cvt_pk_bf16_f32 v18, v34, v35
    ds_read_b128 v[118:121], v1 offset:32768
    v_cvt_pk_bf16_f32 v19, v36, v37
    ds_read_b128 v[42:45], v1 offset:34816
    v_cvt_pk_bf16_f32 v20, v38, v39
    ds_read_b128 v[46:49], v1 offset:33792
    v_cvt_pk_bf16_f32 v21, v40, v41
    ds_read_b128 v[50:53], v1 offset:35840
    s_waitcnt lgkmcnt(4)
    v_pk_add_f32 v[78:79], v[78:79], v[80:81]
    v_pk_add_f32 v[82:83], v[82:83], v[84:85]
    v_pk_add_f32 v[78:79], v[78:79], v[82:83]
    v_mul_f32 v80, s56, v78
    v_add_f32 v79, s58, v79
    v_fma_f32 v79, -v78, v80, v79
    v_max_f32 v79, s58, v79
    v_rsq_f32 v86, v79
    v_mul_f32 v80, s62, v80
    v_mul_f32 v87, -v80, v86
    v_mul_f32 v86, s62, v86
    v_pk_fma_f32 v[78:79], v[34:35], v[86:87], v[86:87] op_sel:[0,0,1] op_sel_hi:[1,0,1]
    v_pk_fma_f32 v[80:81], v[36:37], v[86:87], v[86:87] op_sel:[0,0,1] op_sel_hi:[1,0,1]
    v_pk_fma_f32 v[82:83], v[38:39], v[86:87], v[86:87] op_sel:[0,0,1] op_sel_hi:[1,0,1]
    v_pk_fma_f32 v[84:85], v[40:41], v[86:87], v[86:87] op_sel:[0,0,1] op_sel_hi:[1,0,1]
    v_cvt_pk_bf16_f32 v78, v78, v79
    v_cvt_pk_bf16_f32 v79, v80, v81
    v_cvt_pk_bf16_f32 v80, v82, v83
    v_cvt_pk_bf16_f32 v81, v84, v85
    buffer_store_dwordx4 v[78:81], v9, s[32:35], s50 offen
    s_waitcnt lgkmcnt(3)
    v_mfma_f32_16x16x32_bf16 v[62:65], v[128:131], v[118:121], 0
    s_waitcnt lgkmcnt(2)
    ds_read_b128 v[54:57], v1 offset:36864
    v_mfma_f32_16x16x32_bf16 v[62:65], v[110:113], v[42:45], v[62:65]
    s_waitcnt lgkmcnt(2)
    ds_read_b64_tr_b16 v[94:95], v13 offset:4096
    ds_read_b64_tr_b16 v[96:97], v13 offset:6144
    v_mfma_f32_16x16x32_bf16 v[70:73], v[128:131], v[46:49], 0
    s_waitcnt lgkmcnt(3)
    ds_read_b128 v[98:101], v1 offset:38912
    v_mfma_f32_16x16x32_bf16 v[70:73], v[110:113], v[50:53], v[70:73]
    ds_read_b128 v[102:105], v1 offset:37888
    v_mfma_f32_16x16x32_bf16 v[74:77], v[132:135], v[46:49], 0
    ds_read_b128 v[106:109], v1 offset:39936
    v_mfma_f32_16x16x32_bf16 v[74:77], v[114:117], v[50:53], v[74:77]
    ds_read_b64_tr_b16 v[34:35], v127 offset:4096
    ds_read_b64_tr_b16 v[36:37], v127 offset:6144
    v_mfma_f32_16x16x32_bf16 v[66:69], v[132:135], v[118:121], 0
    ds_read_b128 v[38:41], v1 offset:40960
    v_mfma_f32_16x16x32_bf16 v[66:69], v[114:117], v[42:45], v[66:69]
    s_waitcnt lgkmcnt(8)
    ds_read_b64_tr_b16 v[110:111], v13 offset:8192
    ds_read_b64_tr_b16 v[112:113], v13 offset:10240
    v_mfma_f32_16x16x32_bf16 v[62:65], v[136:139], v[54:57], v[62:65]
    s_waitcnt lgkmcnt(7)
    ds_read_b128 v[46:49], v1 offset:43008
    v_mfma_f32_16x16x32_bf16 v[62:65], v[94:97], v[98:101], v[62:65]
    s_waitcnt lgkmcnt(7)
    ds_read_b128 v[118:121], v1 offset:41984
    v_mfma_f32_16x16x32_bf16 v[70:73], v[136:139], v[102:105], v[70:73]
    s_waitcnt lgkmcnt(7)
    ds_read_b128 v[114:117], v1 offset:44032
    v_mfma_f32_16x16x32_bf16 v[70:73], v[94:97], v[106:109], v[70:73]
    ds_read_b64_tr_b16 v[94:95], v127 offset:8192
    ds_read_b64_tr_b16 v[96:97], v127 offset:10240
    v_mfma_f32_16x16x32_bf16 v[74:77], v[140:143], v[102:105], v[74:77]
    s_waitcnt lgkmcnt(8)
    ds_read_b128 v[102:105], v1 offset:45056
    v_mfma_f32_16x16x32_bf16 v[74:77], v[34:37], v[106:109], v[74:77]
    v_mfma_f32_16x16x32_bf16 v[66:69], v[140:143], v[54:57], v[66:69]
    ds_read_b128 v[54:57], v1 offset:46080
    v_mfma_f32_16x16x32_bf16 v[66:69], v[34:37], v[98:101], v[66:69]
    s_waitcnt lgkmcnt(9)
    ds_read_b128 v[34:37], v1 offset:32768
    v_mfma_f32_16x16x32_bf16 v[62:65], v[144:147], v[38:41], v[62:65]
    s_waitcnt lgkmcnt(7)
    v_mfma_f32_16x16x32_bf16 v[62:65], v[110:113], v[46:49], v[62:65]
    s_waitcnt lgkmcnt(6)
    v_mfma_f32_16x16x32_bf16 v[70:73], v[144:147], v[118:121], v[70:73]
    s_waitcnt lgkmcnt(5)
    v_mfma_f32_16x16x32_bf16 v[70:73], v[110:113], v[114:117], v[70:73]
    ds_read_b64_tr_b16 v[110:111], v125 offset:0
    ds_read_b64_tr_b16 v[112:113], v125 offset:2048
    v_mfma_f32_16x16x32_bf16 v[74:77], v[148:151], v[118:121], v[74:77]
    s_waitcnt lgkmcnt(5)
    ds_read_b128 v[118:121], v1 offset:33792
    v_mfma_f32_16x16x32_bf16 v[74:77], v[94:97], v[114:117], v[74:77]
    v_mfma_f32_16x16x32_bf16 v[66:69], v[148:151], v[38:41], v[66:69]
    ds_read_b64_tr_b16 v[38:39], v122 offset:0
    ds_read_b64_tr_b16 v[40:41], v122 offset:2048
    v_mfma_f32_16x16x32_bf16 v[66:69], v[94:97], v[46:49], v[66:69]
    s_waitcnt lgkmcnt(7)
    ds_read_b128 v[94:97], v1 offset:36864
    v_mfma_f32_16x16x32_bf16 v[62:65], v[152:155], v[102:105], v[62:65]
    s_waitcnt lgkmcnt(7)
    v_mfma_f32_16x16x32_bf16 v[70:73], v[152:155], v[54:57], v[70:73]
    v_mfma_f32_16x16x32_bf16 v[74:77], v[156:159], v[54:57], v[74:77]
    ds_read_b64_tr_b16 v[54:55], v125 offset:4096
    ds_read_b64_tr_b16 v[56:57], v125 offset:6144
    v_mfma_f32_16x16x32_bf16 v[66:69], v[156:159], v[102:105], v[66:69]
    s_waitcnt lgkmcnt(8)
    ds_read_b128 v[102:105], v1 offset:37888
    v_mfma_f32_16x16x32_bf16 v[78:81], v[160:163], v[34:37], 0
    s_waitcnt lgkmcnt(7)
    v_mfma_f32_16x16x32_bf16 v[78:81], v[110:113], v[42:45], v[78:81]
    s_waitcnt lgkmcnt(6)
    v_mfma_f32_16x16x32_bf16 v[86:89], v[160:163], v[118:121], 0
    s_waitcnt vmcnt(0)
    buffer_store_byte v0, off, s[32:35], s44 offset:192
    v_mfma_f32_16x16x32_bf16 v[86:89], v[110:113], v[50:53], v[86:89]
    ds_read_b64_tr_b16 v[110:111], v122 offset:4096
    ds_read_b64_tr_b16 v[112:113], v122 offset:6144
    v_mfma_f32_16x16x32_bf16 v[90:93], v[164:167], v[118:121], 0
    s_waitcnt lgkmcnt(6)
    ds_read_b128 v[118:121], v1 offset:40960
    v_cvt_pk_bf16_f32 v70, v70, v71
    v_mfma_f32_16x16x32_bf16 v[90:93], v[38:41], v[50:53], v[90:93]
    v_cvt_pk_bf16_f32 v71, v72, v73
    v_cvt_pk_bf16_f32 v72, v74, v75
    v_mfma_f32_16x16x32_bf16 v[82:85], v[164:167], v[34:37], 0
    ds_read_b64_tr_b16 v[34:35], v125 offset:8192
    ds_read_b64_tr_b16 v[36:37], v125 offset:10240
    v_mfma_f32_16x16x32_bf16 v[82:85], v[38:41], v[42:45], v[82:85]
    s_waitcnt lgkmcnt(8)
    ds_read_b128 v[38:41], v1 offset:41984
    v_cvt_pk_bf16_f32 v73, v76, v77
    v_mfma_f32_16x16x32_bf16 v[78:81], v[168:171], v[94:97], v[78:81]
    s_waitcnt lgkmcnt(7)
    v_cmp_ne_u32 vcc, s46, v123
    v_cvt_pk_bf16_f32 v62, v62, v63
    v_mfma_f32_16x16x32_bf16 v[78:81], v[54:57], v[98:101], v[78:81]
    s_waitcnt lgkmcnt(6)
    v_cvt_pk_bf16_f32 v63, v64, v65
    v_cvt_pk_bf16_f32 v64, v66, v67
    v_mfma_f32_16x16x32_bf16 v[86:89], v[168:171], v[102:105], v[86:89]
    s_cbranch_vccnz L4_wait5
L4_got5:
    v_cvt_pk_bf16_f32 v65, v68, v69
    v_mfma_f32_16x16x32_bf16 v[86:89], v[54:57], v[106:109], v[86:89]
    ds_read_b64_tr_b16 v[54:55], v122 offset:8192
    ds_read_b64_tr_b16 v[56:57], v122 offset:10240
    v_mfma_f32_16x16x32_bf16 v[90:93], v[172:175], v[102:105], v[90:93]
    s_waitcnt lgkmcnt(6)
    buffer_store_dwordx4 v[70:73], v7, s[32:35], s53 offen offset:0
    v_mfma_f32_16x16x32_bf16 v[90:93], v[110:113], v[106:109], v[90:93]
    ds_read_b128 v[102:105], v1 offset:45056
    v_mfma_f32_16x16x32_bf16 v[82:85], v[172:175], v[94:97], v[82:85]
    ds_read_b128 v[94:97], v1 offset:46080
    v_mfma_f32_16x16x32_bf16 v[82:85], v[110:113], v[98:101], v[82:85]
    s_waitcnt lgkmcnt(7)
    ds_read_b128 v[110:113], v1 offset:32768
    v_mfma_f32_16x16x32_bf16 v[78:81], v[176:179], v[118:121], v[78:81]
    s_waitcnt lgkmcnt(6)
    v_mfma_f32_16x16x32_bf16 v[78:81], v[34:37], v[46:49], v[78:81]
    s_waitcnt lgkmcnt(5)
    v_mfma_f32_16x16x32_bf16 v[86:89], v[176:179], v[38:41], v[86:89]
    buffer_load_dword v123, v3, s[32:35], s47 offen offset:192 sc1
    v_mfma_f32_16x16x32_bf16 v[86:89], v[34:37], v[114:117], v[86:89]
    ds_read_b64_tr_b16 v[34:35], v13 offset:12288
    ds_read_b64_tr_b16 v[36:37], v13 offset:14336
    v_mfma_f32_16x16x32_bf16 v[90:93], v[180:183], v[38:41], v[90:93]
    s_waitcnt lgkmcnt(5)
    ds_read_b128 v[38:41], v1 offset:33792
    v_mfma_f32_16x16x32_bf16 v[90:93], v[54:57], v[114:117], v[90:93]
    v_mfma_f32_16x16x32_bf16 v[82:85], v[180:183], v[118:121], v[82:85]
    buffer_store_dwordx4 v[62:65], v7, s[32:35], s52 offen offset:0
    v_mfma_f32_16x16x32_bf16 v[82:85], v[54:57], v[46:49], v[82:85]
    s_waitcnt lgkmcnt(5)
    ds_read_b64_tr_b16 v[118:119], v127 offset:12288
    ds_read_b64_tr_b16 v[120:121], v127 offset:14336
    v_mfma_f32_16x16x32_bf16 v[78:81], v[184:187], v[102:105], v[78:81]
    s_waitcnt lgkmcnt(6)
    ds_read_b128 v[54:57], v1 offset:36864
    v_mfma_f32_16x16x32_bf16 v[86:89], v[184:187], v[94:97], v[86:89]
    v_mfma_f32_16x16x32_bf16 v[90:93], v[188:191], v[94:97], v[90:93]
    ds_read_b64_tr_b16 v[94:95], v13 offset:16384
    ds_read_b64_tr_b16 v[96:97], v13 offset:18432
    v_mfma_f32_16x16x32_bf16 v[82:85], v[188:191], v[102:105], v[82:85]
    s_waitcnt lgkmcnt(8)
    ds_read_b128 v[102:105], v1 offset:37888
    v_mfma_f32_16x16x32_bf16 v[62:65], v[192:195], v[110:113], 0
    s_waitcnt lgkmcnt(7)
    v_mfma_f32_16x16x32_bf16 v[62:65], v[34:37], v[42:45], v[62:65]
    s_waitcnt lgkmcnt(6)
    v_mfma_f32_16x16x32_bf16 v[70:73], v[192:195], v[38:41], 0
    v_cvt_pk_bf16_f32 v86, v86, v87
    v_cvt_pk_bf16_f32 v87, v88, v89
    v_mfma_f32_16x16x32_bf16 v[70:73], v[34:37], v[50:53], v[70:73]
    ds_read_b64_tr_b16 v[34:35], v127 offset:16384
    ds_read_b64_tr_b16 v[36:37], v127 offset:18432
    v_mfma_f32_16x16x32_bf16 v[74:77], v[196:199], v[38:41], 0
    s_waitcnt lgkmcnt(6)
    ds_read_b128 v[38:41], v1 offset:40960
    v_cvt_pk_bf16_f32 v88, v90, v91
    v_mfma_f32_16x16x32_bf16 v[74:77], v[118:121], v[50:53], v[74:77]
    v_cvt_pk_bf16_f32 v89, v92, v93
    v_cvt_pk_bf16_f32 v78, v78, v79
    v_mfma_f32_16x16x32_bf16 v[66:69], v[196:199], v[110:113], 0
    ds_read_b64_tr_b16 v[110:111], v13 offset:20480
    ds_read_b64_tr_b16 v[112:113], v13 offset:22528
    v_mfma_f32_16x16x32_bf16 v[66:69], v[118:121], v[42:45], v[66:69]
    s_waitcnt lgkmcnt(8)
    ds_read_b128 v[118:121], v1 offset:41984
    v_cvt_pk_bf16_f32 v79, v80, v81
    v_mfma_f32_16x16x32_bf16 v[62:65], v[200:203], v[54:57], v[62:65]
    s_waitcnt lgkmcnt(7)
    v_cvt_pk_bf16_f32 v80, v82, v83
    v_cvt_pk_bf16_f32 v81, v84, v85
    v_mfma_f32_16x16x32_bf16 v[62:65], v[94:97], v[98:101], v[62:65]
    s_waitcnt lgkmcnt(6)
    v_mfma_f32_16x16x32_bf16 v[70:73], v[200:203], v[102:105], v[70:73]
    v_mfma_f32_16x16x32_bf16 v[70:73], v[94:97], v[106:109], v[70:73]
    ds_read_b64_tr_b16 v[94:95], v127 offset:20480
    ds_read_b64_tr_b16 v[96:97], v127 offset:22528
    v_mfma_f32_16x16x32_bf16 v[74:77], v[204:207], v[102:105], v[74:77]
    s_waitcnt lgkmcnt(6)
    buffer_store_dwordx4 v[86:89], v7, s[32:35], s53 offen offset:256
    v_mfma_f32_16x16x32_bf16 v[74:77], v[34:37], v[106:109], v[74:77]
    ds_read_b128 v[102:105], v1 offset:45056
    v_mfma_f32_16x16x32_bf16 v[66:69], v[204:207], v[54:57], v[66:69]
    ds_read_b128 v[54:57], v1 offset:46080
    v_mfma_f32_16x16x32_bf16 v[66:69], v[34:37], v[98:101], v[66:69]
    s_waitcnt lgkmcnt(7)
    ds_read_b128 v[34:37], v1 offset:32768
    v_mfma_f32_16x16x32_bf16 v[62:65], v[208:211], v[38:41], v[62:65]
    s_waitcnt vmcnt(2) lgkmcnt(6)
    v_cmp_ne_u32 vcc, s46, v123
    v_mfma_f32_16x16x32_bf16 v[62:65], v[110:113], v[46:49], v[62:65]
    s_waitcnt lgkmcnt(5)
    v_mfma_f32_16x16x32_bf16 v[70:73], v[208:211], v[118:121], v[70:73]
    s_cbranch_vccnz L4_wait6
L4_got6:
    s_add_u32 m0, s55, 0
    s_add_u32 s76, s54, 32768
    buffer_load_dwordx4 v1, s[32:35], s76 offen offset:0 sc1 lds
    v_mfma_f32_16x16x32_bf16 v[70:73], v[110:113], v[114:117], v[70:73]
    ds_read_b64_tr_b16 v[110:111], v125 offset:12288
    ds_read_b64_tr_b16 v[112:113], v125 offset:14336
    v_mfma_f32_16x16x32_bf16 v[74:77], v[212:215], v[118:121], v[74:77]
    s_waitcnt lgkmcnt(5)
    ds_read_b128 v[118:121], v1 offset:33792
    v_mfma_f32_16x16x32_bf16 v[74:77], v[94:97], v[114:117], v[74:77]
    v_mfma_f32_16x16x32_bf16 v[66:69], v[212:215], v[38:41], v[66:69]
    buffer_store_dwordx4 v[78:81], v7, s[32:35], s52 offen offset:256
    v_mfma_f32_16x16x32_bf16 v[66:69], v[94:97], v[46:49], v[66:69]
    s_waitcnt lgkmcnt(5)
    buffer_load_dwordx4 v1, s[32:35], s76 offen offset:1024 sc1 lds
    v_mfma_f32_16x16x32_bf16 v[62:65], v[216:219], v[102:105], v[62:65]
    s_waitcnt lgkmcnt(4)
    ds_read_b64_tr_b16 v[38:39], v122 offset:12288
    ds_read_b64_tr_b16 v[40:41], v122 offset:14336
    v_mfma_f32_16x16x32_bf16 v[70:73], v[216:219], v[54:57], v[70:73]
    s_add_u32 m0, s55, 8192
    ds_read_b128 v[94:97], v1 offset:36864
    v_mfma_f32_16x16x32_bf16 v[74:77], v[220:223], v[54:57], v[74:77]
    s_add_u32 s76, s54, 40960
    ds_read_b64_tr_b16 v[54:55], v125 offset:16384
    ds_read_b64_tr_b16 v[56:57], v125 offset:18432
    v_mfma_f32_16x16x32_bf16 v[66:69], v[220:223], v[102:105], v[66:69]
    s_waitcnt lgkmcnt(8)
    buffer_load_dwordx4 v1, s[32:35], s76 offen offset:0 sc1 lds
    v_mfma_f32_16x16x32_bf16 v[78:81], v[224:227], v[34:37], 0
    s_waitcnt lgkmcnt(6)
    ds_read_b128 v[102:105], v1 offset:37888
    v_mfma_f32_16x16x32_bf16 v[78:81], v[110:113], v[42:45], v[78:81]
    s_waitcnt lgkmcnt(6)
    v_mfma_f32_16x16x32_bf16 v[86:89], v[224:227], v[118:121], 0
    v_cvt_pk_bf16_f32 v70, v70, v71
    v_cvt_pk_bf16_f32 v71, v72, v73
    v_mfma_f32_16x16x32_bf16 v[86:89], v[110:113], v[50:53], v[86:89]
    buffer_load_dwordx4 v1, s[32:35], s76 offen offset:1024 sc1 lds
    v_mfma_f32_16x16x32_bf16 v[90:93], v[228:231], v[118:121], 0
    s_waitcnt lgkmcnt(4)
    ds_read_b64_tr_b16 v[110:111], v122 offset:16384
    ds_read_b64_tr_b16 v[112:113], v122 offset:18432
    v_mfma_f32_16x16x32_bf16 v[90:93], v[38:41], v[50:53], v[90:93]
    s_add_u32 m0, s55, 16384
    ds_read_b128 v[118:121], v1 offset:40960
    v_cvt_pk_bf16_f32 v72, v74, v75
    v_mfma_f32_16x16x32_bf16 v[82:85], v[228:231], v[34:37], 0
    s_add_u32 s76, s54, 49152
    ds_read_b64_tr_b16 v[50:51], v125 offset:20480
    ds_read_b64_tr_b16 v[52:53], v125 offset:22528
    v_mfma_f32_16x16x32_bf16 v[82:85], v[38:41], v[42:45], v[82:85]
    s_waitcnt lgkmcnt(8)
    buffer_load_dwordx4 v1, s[32:35], s76 offen offset:0 sc1 lds
    v_mfma_f32_16x16x32_bf16 v[78:81], v[232:235], v[94:97], v[78:81]
    s_waitcnt lgkmcnt(6)
    ds_read_b128 v[34:37], v1 offset:41984
    v_cvt_pk_bf16_f32 v73, v76, v77
    v_mfma_f32_16x16x32_bf16 v[78:81], v[54:57], v[98:101], v[78:81]
    s_waitcnt lgkmcnt(6)
    ds_read_b64_tr_b16 v[38:39], v122 offset:20480
    ds_read_b64_tr_b16 v[40:41], v122 offset:22528
    v_mfma_f32_16x16x32_bf16 v[86:89], v[232:235], v[102:105], v[86:89]
    ds_read_b128 v[42:45], v1 offset:45056
    v_cvt_pk_bf16_f32 v62, v62, v63
    v_mfma_f32_16x16x32_bf16 v[86:89], v[54:57], v[106:109], v[86:89]
    buffer_load_dwordx4 v1, s[32:35], s76 offen offset:1024 sc1 lds
    v_mfma_f32_16x16x32_bf16 v[90:93], v[236:239], v[102:105], v[90:93]
    s_waitcnt lgkmcnt(7)
    buffer_store_dwordx4 v[70:73], v7, s[32:35], s53 offen offset:512
    v_mfma_f32_16x16x32_bf16 v[90:93], v[110:113], v[106:109], v[90:93]
    s_add_u32 m0, s55, 24576
    ds_read_b128 v[54:57], v1 offset:46080
    v_cvt_pk_bf16_f32 v63, v64, v65
    v_mfma_f32_16x16x32_bf16 v[82:85], v[236:239], v[94:97], v[82:85]
    s_add_u32 s76, s54, 57344
    v_cvt_pk_bf16_f32 v64, v66, v67
    v_cvt_pk_bf16_f32 v65, v68, v69
    v_mfma_f32_16x16x32_bf16 v[82:85], v[110:113], v[98:101], v[82:85]
    s_waitcnt lgkmcnt(7)
    buffer_load_dwordx4 v1, s[32:35], s76 offen offset:0 sc1 lds
    v_mfma_f32_16x16x32_bf16 v[78:81], v[240:243], v[118:121], v[78:81]
    s_waitcnt lgkmcnt(5)
    v_mfma_f32_16x16x32_bf16 v[78:81], v[50:53], v[46:49], v[78:81]
    s_waitcnt lgkmcnt(4)
    v_mfma_f32_16x16x32_bf16 v[86:89], v[240:243], v[34:37], v[86:89]
    v_mfma_f32_16x16x32_bf16 v[86:89], v[50:53], v[114:117], v[86:89]
    buffer_load_dwordx4 v1, s[32:35], s76 offen offset:1024 sc1 lds
    v_mfma_f32_16x16x32_bf16 v[90:93], v[244:247], v[34:37], v[90:93]
    s_waitcnt lgkmcnt(2)
    v_mfma_f32_16x16x32_bf16 v[90:93], v[38:41], v[114:117], v[90:93]
    v_mfma_f32_16x16x32_bf16 v[82:85], v[244:247], v[118:121], v[82:85]
    buffer_store_dwordx4 v[62:65], v7, s[32:35], s52 offen offset:512
    v_mfma_f32_16x16x32_bf16 v[82:85], v[38:41], v[46:49], v[82:85]
    s_waitcnt lgkmcnt(1)
    v_mfma_f32_16x16x32_bf16 v[78:81], v[248:251], v[42:45], v[78:81]
    s_waitcnt lgkmcnt(0)
    v_mfma_f32_16x16x32_bf16 v[86:89], v[248:251], v[54:57], v[86:89]
    v_mfma_f32_16x16x32_bf16 v[90:93], v[252:255], v[54:57], v[90:93]
    v_mfma_f32_16x16x32_bf16 v[82:85], v[252:255], v[42:45], v[82:85]
    s_waitcnt vmcnt(8)
    s_barrier
    ds_read_b128 v[34:37], v2 offset:0
    ds_read_b128 v[38:41], v2 offset:2048
    ds_read_b128 v[42:45], v2 offset:4096
    ds_read_b128 v[46:49], v2 offset:6144
    v_cvt_pk_bf16_f32 v86, v86, v87
    v_cvt_pk_bf16_f32 v87, v88, v89
    v_cvt_pk_bf16_f32 v88, v90, v91
    v_cvt_pk_bf16_f32 v89, v92, v93
LP_5:
    s_cbranch_execz LP_back
    buffer_store_dwordx4 v[86:89], v124, s[32:35], s26 offen
    v_cvt_pk_bf16_f32 v78, v78, v79
    v_cvt_pk_bf16_f32 v79, v80, v81
    v_cvt_pk_bf16_f32 v80, v82, v83
    v_cvt_pk_bf16_f32 v81, v84, v85
    buffer_store_dwordx4 v[78:81], v124, s[32:35], s81 offen
    s_waitcnt lgkmcnt(2)
    v_mfma_f32_16x16x32_bf16 v[110:113], a[0:3], v[34:37], 0
    s_waitcnt vmcnt(8)
    s_barrier
    ds_read_b128 v[50:53], v2 offset:8192
    v_mfma_f32_16x16x32_bf16 v[110:113], a[16:19], v[38:41], v[110:113]
    ds_read_b128 v[54:57], v2 offset:10240
    v_mfma_f32_16x16x32_bf16 v[114:117], a[4:7], v[34:37], 0
    v_mfma_f32_16x16x32_bf16 v[114:117], a[20:23], v[38:41], v[114:117]
    v_mfma_f32_16x16x32_bf16 v[118:121], a[8:11], v[34:37], 0
    v_mfma_f32_16x16x32_bf16 v[118:121], a[24:27], v[38:41], v[118:121]
    s_waitcnt lgkmcnt(2)
    v_mfma_f32_16x16x32_bf16 v[110:113], a[32:35], v[42:45], v[110:113]
    ds_read_b128 v[34:37], v2 offset:12288
    v_mfma_f32_16x16x32_bf16 v[110:113], a[48:51], v[46:49], v[110:113]
    ds_read_b128 v[38:41], v2 offset:14336
    v_mfma_f32_16x16x32_bf16 v[114:117], a[36:39], v[42:45], v[114:117]
    v_mfma_f32_16x16x32_bf16 v[114:117], a[52:55], v[46:49], v[114:117]
    v_mfma_f32_16x16x32_bf16 v[118:121], a[40:43], v[42:45], v[118:121]
    v_mfma_f32_16x16x32_bf16 v[118:121], a[56:59], v[46:49], v[118:121]
    s_waitcnt lgkmcnt(2)
    v_mfma_f32_16x16x32_bf16 v[110:113], a[64:67], v[50:53], v[110:113]
    s_waitcnt vmcnt(6)
    s_barrier
    ds_read_b128 v[42:45], v2 offset:16384
    v_mfma_f32_16x16x32_bf16 v[110:113], a[80:83], v[54:57], v[110:113]
    ds_read_b128 v[46:49], v2 offset:18432
    v_mfma_f32_16x16x32_bf16 v[114:117], a[68:71], v[50:53], v[114:117]
    v_mfma_f32_16x16x32_bf16 v[114:117], a[84:87], v[54:57], v[114:117]
    v_mfma_f32_16x16x32_bf16 v[118:121], a[72:75], v[50:53], v[118:121]
    v_mfma_f32_16x16x32_bf16 v[118:121], a[88:91], v[54:57], v[118:121]
    s_waitcnt lgkmcnt(2)
    v_mfma_f32_16x16x32_bf16 v[110:113], a[96:99], v[34:37], v[110:113]
    ds_read_b128 v[50:53], v2 offset:20480
    v_mfma_f32_16x16x32_bf16 v[110:113], a[112:115], v[38:41], v[110:113]
    ds_read_b128 v[54:57], v2 offset:22528
    v_mfma_f32_16x16x32_bf16 v[114:117], a[100:103], v[34:37], v[114:117]
    v_mfma_f32_16x16x32_bf16 v[114:117], a[116:119], v[38:41], v[114:117]
    v_mfma_f32_16x16x32_bf16 v[118:121], a[104:107], v[34:37], v[118:121]
    v_mfma_f32_16x16x32_bf16 v[118:121], a[120:123], v[38:41], v[118:121]
    s_waitcnt lgkmcnt(2)
    v_mfma_f32_16x16x32_bf16 v[110:113], a[128:131], v[42:45], v[110:113]
    s_waitcnt vmcnt(3)
    s_barrier
    ds_read_b128 v[34:37], v2 offset:24576
    v_mfma_f32_16x16x32_bf16 v[110:113], a[144:147], v[46:49], v[110:113]
    ds_read_b128 v[38:41], v2 offset:26624
    v_mfma_f32_16x16x32_bf16 v[114:117], a[132:135], v[42:45], v[114:117]
    v_mfma_f32_16x16x32_bf16 v[114:117], a[148:151], v[46:49], v[114:117]
    v_mfma_f32_16x16x32_bf16 v[118:121], a[136:139], v[42:45], v[118:121]
    s_waitcnt vmcnt(0)
    buffer_store_byte v0, off, s[32:35], s44 offset:224
    v_mfma_f32_16x16x32_bf16 v[118:121], a[152:155], v[46:49], v[118:121]
    s_waitcnt lgkmcnt(2)
    v_mfma_f32_16x16x32_bf16 v[110:113], a[160:163], v[50:53], v[110:113]
    ds_read_b128 v[42:45], v2 offset:28672
    v_mfma_f32_16x16x32_bf16 v[110:113], a[176:179], v[54:57], v[110:113]
    ds_read_b128 v[46:49], v2 offset:30720
    v_xor_b32 v2, 1024, v2
    v_mfma_f32_16x16x32_bf16 v[114:117], a[164:167], v[50:53], v[114:117]
    v_mfma_f32_16x16x32_bf16 v[114:117], a[180:183], v[54:57], v[114:117]
    v_mfma_f32_16x16x32_bf16 v[118:121], a[168:171], v[50:53], v[118:121]
    v_mfma_f32_16x16x32_bf16 v[118:121], a[184:187], v[54:57], v[118:121]
    s_waitcnt lgkmcnt(2)
    v_mfma_f32_16x16x32_bf16 v[110:113], a[192:195], v[34:37], v[110:113]
    ds_read_b128 v[50:53], v2 offset:0
    v_mfma_f32_16x16x32_bf16 v[110:113], a[208:211], v[38:41], v[110:113]
    ds_read_b128 v[54:57], v2 offset:2048
    v_mfma_f32_16x16x32_bf16 v[114:117], a[196:199], v[34:37], v[114:117]
    v_mfma_f32_16x16x32_bf16 v[114:117], a[212:215], v[38:41], v[114:117]
    v_mfma_f32_16x16x32_bf16 v[118:121], a[200:203], v[34:37], v[118:121]
    v_mfma_f32_16x16x32_bf16 v[118:121], a[216:219], v[38:41], v[118:121]
    s_waitcnt lgkmcnt(2)
    v_mfma_f32_16x16x32_bf16 v[110:113], a[224:227], v[42:45], v[110:113]
    ds_read_b128 v[34:37], v2 offset:4096
    v_mfma_f32_16x16x32_bf16 v[110:113], a[240:243], v[46:49], v[110:113]
    ds_read_b128 v[38:41], v2 offset:6144
    v_mfma_f32_16x16x32_bf16 v[114:117], a[228:231], v[42:45], v[114:117]
    v_mfma_f32_16x16x32_bf16 v[114:117], a[244:247], v[46:49], v[114:117]
    buffer_load_dword v123, v3, s[32:35], s47 offen offset:224 sc1
    v_mfma_f32_16x16x32_bf16 v[118:121], a[232:235], v[42:45], v[118:121]
    v_mfma_f32_16x16x32_bf16 v[118:121], a[248:251], v[46:49], v[118:121]
    s_waitcnt lgkmcnt(2)
    v_mfma_f32_16x16x32_bf16 v[94:97], a[0:3], v[50:53], 0
    ds_read_b128 v[42:45], v2 offset:8192
    v_mfma_f32_16x16x32_bf16 v[94:97], a[16:19], v[54:57], v[94:97]
    ds_read_b128 v[46:49], v2 offset:10240
    v_mfma_f32_16x16x32_bf16 v[98:101], a[4:7], v[50:53], 0
    v_exp_f32 v30, -v110
    v_mfma_f32_16x16x32_bf16 v[98:101], a[20:23], v[54:57], v[98:101]
    v_exp_f32 v31, -v111
    v_mfma_f32_16x16x32_bf16 v[102:105], a[8:11], v[50:53], 0
    v_exp_f32 v32, -v112
    v_mfma_f32_16x16x32_bf16 v[102:105], a[24:27], v[54:57], v[102:105]
    v_exp_f32 v33, -v113
    v_mfma_f32_16x16x32_bf16 v[106:109], a[12:15], v[50:53], 0
    v_add_f32 v30, 1.0, v30
    v_add_f32 v31, 1.0, v31
    v_mfma_f32_16x16x32_bf16 v[106:109], a[28:31], v[54:57], v[106:109]
    s_waitcnt lgkmcnt(2)
    v_rcp_f32 v30, v30
    v_mfma_f32_16x16x32_bf16 v[94:97], a[32:35], v[34:37], v[94:97]
    ds_read_b128 v[50:53], v2 offset:12288
    v_mul_f32 v110, v110, v30
    v_mfma_f32_16x16x32_bf16 v[94:97], a[48:51], v[38:41], v[94:97]
    ds_read_b128 v[54:57], v2 offset:14336
    v_add_f32 v32, 1.0, v32
    v_mfma_f32_16x16x32_bf16 v[98:101], a[36:39], v[34:37], v[98:101]
    v_rcp_f32 v31, v31
    v_mfma_f32_16x16x32_bf16 v[98:101], a[52:55], v[38:41], v[98:101]
    v_rcp_f32 v32, v32
    v_mfma_f32_16x16x32_bf16 v[102:105], a[40:43], v[34:37], v[102:105]
    v_exp_f32 v30, -v114
    v_mfma_f32_16x16x32_bf16 v[102:105], a[56:59], v[38:41], v[102:105]
    v_mul_f32 v111, v111, v31
    v_cvt_pk_bf16_f32 v110, v110, v111
    v_mfma_f32_16x16x32_bf16 v[106:109], a[44:47], v[34:37], v[106:109]
    v_exp_f32 v31, -v115
    v_mfma_f32_16x16x32_bf16 v[106:109], a[60:63], v[38:41], v[106:109]
    s_waitcnt lgkmcnt(2)
    v_mul_f32 v112, v112, v32
    v_add_f32 v33, 1.0, v33
    v_mfma_f32_16x16x32_bf16 v[94:97], a[64:67], v[42:45], v[94:97]
    ds_read_b128 v[34:37], v2 offset:16384
    v_add_f32 v30, 1.0, v30
    v_mfma_f32_16x16x32_bf16 v[94:97], a[80:83], v[46:49], v[94:97]
    ds_read_b128 v[38:41], v2 offset:18432
    v_add_f32 v31, 1.0, v31
    v_mfma_f32_16x16x32_bf16 v[98:101], a[68:71], v[42:45], v[98:101]
    v_rcp_f32 v33, v33
    v_mfma_f32_16x16x32_bf16 v[98:101], a[84:87], v[46:49], v[98:101]
    v_rcp_f32 v30, v30
    v_mfma_f32_16x16x32_bf16 v[102:105], a[72:75], v[42:45], v[102:105]
    s_waitcnt vmcnt(0)
    v_cmp_ne_u32 vcc, s46, v123
    v_mul_f32 v113, v113, v33
    v_mfma_f32_16x16x32_bf16 v[102:105], a[88:91], v[46:49], v[102:105]
    v_cvt_pk_bf16_f32 v111, v112, v113
    v_mul_f32 v114, v114, v30
    v_mfma_f32_16x16x32_bf16 v[106:109], a[76:79], v[42:45], v[106:109]
    s_cbranch_vccnz L4_wait7
L4_got7:
    buffer_load_dwordx4 v[62:65], v8, s[32:35], s88 offen sc1
    v_mfma_f32_16x16x32_bf16 v[106:109], a[92:95], v[46:49], v[106:109]
    s_waitcnt lgkmcnt(2)
    ds_write_b64 v4, v[110:111] offset:0
    v_mfma_f32_16x16x32_bf16 v[94:97], a[96:99], v[50:53], v[94:97]
    ds_read_b128 v[42:45], v2 offset:20480
    v_mfma_f32_16x16x32_bf16 v[94:97], a[112:115], v[54:57], v[94:97]
    ds_read_b128 v[46:49], v2 offset:22528
    v_mfma_f32_16x16x32_bf16 v[98:101], a[100:103], v[50:53], v[98:101]
    buffer_load_dwordx4 v[66:69], v8, s[32:35], s89 offen sc1
    v_mfma_f32_16x16x32_bf16 v[98:101], a[116:119], v[54:57], v[98:101]
    v_rcp_f32 v31, v31
    v_mfma_f32_16x16x32_bf16 v[102:105], a[104:107], v[50:53], v[102:105]
    v_exp_f32 v32, -v116
    v_mfma_f32_16x16x32_bf16 v[102:105], a[120:123], v[54:57], v[102:105]
    v_exp_f32 v33, -v117
    v_mfma_f32_16x16x32_bf16 v[106:109], a[108:111], v[50:53], v[106:109]
    buffer_load_dwordx4 v[70:73], v8, s[32:35], s90 offen sc1
    v_mfma_f32_16x16x32_bf16 v[106:109], a[124:127], v[54:57], v[106:109]
    s_waitcnt lgkmcnt(3)
    v_exp_f32 v30, -v118
    v_mfma_f32_16x16x32_bf16 v[94:97], a[128:131], v[34:37], v[94:97]
    ds_read_b128 v[50:53], v2 offset:24576
    v_mul_f32 v115, v115, v31
    v_mfma_f32_16x16x32_bf16 v[94:97], a[144:147], v[38:41], v[94:97]
    ds_read_b128 v[54:57], v2 offset:26624
    v_cvt_pk_bf16_f32 v114, v114, v115
    v_mfma_f32_16x16x32_bf16 v[98:101], a[132:135], v[34:37], v[98:101]
    buffer_load_dwordx4 v[74:77], v8, s[32:35], s91 offen sc1
    v_mfma_f32_16x16x32_bf16 v[98:101], a[148:151], v[38:41], v[98:101]
    v_exp_f32 v31, -v119
    v_mfma_f32_16x16x32_bf16 v[102:105], a[136:139], v[34:37], v[102:105]
    v_add_f32 v32, 1.0, v32
    v_add_f32 v33, 1.0, v33
    v_mfma_f32_16x16x32_bf16 v[102:105], a[152:155], v[38:41], v[102:105]
    v_rcp_f32 v32, v32
    v_mfma_f32_16x16x32_bf16 v[106:109], a[140:143], v[34:37], v[106:109]
    buffer_load_dwordx4 v[78:81], v8, s[32:35], s92 offen sc1
    v_mfma_f32_16x16x32_bf16 v[106:109], a[156:159], v[38:41], v[106:109]
    s_waitcnt lgkmcnt(2)
    v_rcp_f32 v33, v33
    v_mfma_f32_16x16x32_bf16 v[94:97], a[160:163], v[42:45], v[94:97]
    ds_read_b128 v[34:37], v2 offset:28672
    v_mul_f32 v116, v116, v32
    v_mfma_f32_16x16x32_bf16 v[94:97], a[176:179], v[46:49], v[94:97]
    ds_read_b128 v[38:41], v2 offset:30720
    v_xor_b32 v2, 1024, v2
    v_mfma_f32_16x16x32_bf16 v[98:101], a[164:167], v[42:45], v[98:101]
    buffer_load_dwordx4 v[82:85], v8, s[32:35], s93 offen sc1
    v_mfma_f32_16x16x32_bf16 v[98:101], a[180:183], v[46:49], v[98:101]
    v_exp_f32 v32, -v120
    v_mfma_f32_16x16x32_bf16 v[102:105], a[168:171], v[42:45], v[102:105]
    v_mul_f32 v117, v117, v33
    v_cvt_pk_bf16_f32 v115, v116, v117
    v_mfma_f32_16x16x32_bf16 v[102:105], a[184:187], v[46:49], v[102:105]
    ds_write_b64 v4, v[114:115] offset:8
    v_mfma_f32_16x16x32_bf16 v[106:109], a[172:175], v[42:45], v[106:109]
    buffer_load_dwordx4 v[86:89], v8, s[32:35], s94 offen sc1
    v_mfma_f32_16x16x32_bf16 v[106:109], a[188:191], v[46:49], v[106:109]
    s_waitcnt lgkmcnt(3)
    v_exp_f32 v33, -v121
    v_mfma_f32_16x16x32_bf16 v[94:97], a[192:195], v[50:53], v[94:97]
    v_add_f32 v30, 1.0, v30
    v_add_f32 v31, 1.0, v31
    v_mfma_f32_16x16x32_bf16 v[94:97], a[208:211], v[54:57], v[94:97]
    v_rcp_f32 v30, v30
    v_mfma_f32_16x16x32_bf16 v[98:101], a[196:199], v[50:53], v[98:101]
    buffer_load_dwordx4 v[90:93], v8, s[32:35], s95 offen sc1
    v_mfma_f32_16x16x32_bf16 v[98:101], a[212:215], v[54:57], v[98:101]
    v_rcp_f32 v31, v31
    v_mfma_f32_16x16x32_bf16 v[102:105], a[200:203], v[50:53], v[102:105]
    v_mul_f32 v118, v118, v30
    v_mul_f32 v119, v119, v31
    v_mfma_f32_16x16x32_bf16 v[102:105], a[216:219], v[54:57], v[102:105]
    v_cvt_pk_bf16_f32 v118, v118, v119
    v_add_f32 v32, 1.0, v32
    v_mfma_f32_16x16x32_bf16 v[106:109], a[204:207], v[50:53], v[106:109]
    v_rcp_f32 v32, v32
    v_mfma_f32_16x16x32_bf16 v[106:109], a[220:223], v[54:57], v[106:109]
    s_waitcnt lgkmcnt(1)
    v_mul_f32 v120, v120, v32
    v_add_f32 v33, 1.0, v33
    v_mfma_f32_16x16x32_bf16 v[94:97], a[224:227], v[34:37], v[94:97]
    v_rcp_f32 v33, v33
    v_mfma_f32_16x16x32_bf16 v[94:97], a[240:243], v[38:41], v[94:97]
    v_mul_f32 v121, v121, v33
    v_cvt_pk_bf16_f32 v119, v120, v121
    v_mfma_f32_16x16x32_bf16 v[98:101], a[228:231], v[34:37], v[98:101]
    ds_write_b64 v5, v[118:119] offset:0
    v_xor_b32 v4, 1024, v4
    v_xor_b32 v5, 1024, v5
    v_mfma_f32_16x16x32_bf16 v[98:101], a[244:247], v[38:41], v[98:101]
    v_mfma_f32_16x16x32_bf16 v[102:105], a[232:235], v[34:37], v[102:105]
    v_mfma_f32_16x16x32_bf16 v[102:105], a[248:251], v[38:41], v[102:105]
    v_mfma_f32_16x16x32_bf16 v[106:109], a[236:239], v[34:37], v[106:109]
    v_mfma_f32_16x16x32_bf16 v[106:109], a[252:255], v[38:41], v[106:109]
    v_mfma_f32_32x32x16_bf16 v[34:49], v[58:61], v[14:17], 0
    s_waitcnt vmcnt(7)
    v_exp_f32 v30, -v94
    v_exp_f32 v31, -v95
    v_exp_f32 v32, -v96
    v_mfma_f32_32x32x16_bf16 v[34:49], v[58:61], v[62:65], v[34:49]
    s_waitcnt vmcnt(6)
    v_exp_f32 v33, -v97
    v_add_f32 v30, 1.0, v30
    v_add_f32 v31, 1.0, v31
    v_rcp_f32 v30, v30
    v_mfma_f32_32x32x16_bf16 v[34:49], v[58:61], v[66:69], v[34:49]
    s_waitcnt vmcnt(5)
    v_rcp_f32 v31, v31
    v_mul_f32 v94, v94, v30
    v_mul_f32 v95, v95, v31
    v_cvt_pk_bf16_f32 v94, v94, v95
    v_add_f32 v32, 1.0, v32
    v_mfma_f32_32x32x16_bf16 v[34:49], v[58:61], v[70:73], v[34:49]
    s_waitcnt vmcnt(4)
    v_rcp_f32 v32, v32
    v_exp_f32 v30, -v98
    v_exp_f32 v31, -v99
    v_mfma_f32_32x32x16_bf16 v[34:49], v[58:61], v[74:77], v[34:49]
    s_waitcnt vmcnt(3)
    v_mul_f32 v96, v96, v32
    v_add_f32 v33, 1.0, v33
    v_rcp_f32 v33, v33
    v_exp_f32 v32, -v100
    v_mfma_f32_32x32x16_bf16 v[34:49], v[58:61], v[78:81], v[34:49]
    s_waitcnt vmcnt(2)
    v_mul_f32 v97, v97, v33
    v_cvt_pk_bf16_f32 v95, v96, v97
    v_exp_f32 v33, -v101
    v_add_f32 v30, 1.0, v30
    v_add_f32 v31, 1.0, v31
    v_mfma_f32_32x32x16_bf16 v[34:49], v[58:61], v[82:85], v[34:49]
    s_waitcnt vmcnt(1)
    ds_write_b64 v4, v[94:95] offset:0
    v_add_f32 v32, 1.0, v32
    v_rcp_f32 v30, v30
    v_mfma_f32_32x32x16_bf16 v[34:49], v[58:61], v[86:89], v[34:49]
    s_waitcnt vmcnt(0)
    buffer_store_byte v0, off, s[32:35], s44 offset:256
    v_rcp_f32 v31, v31
    v_rcp_f32 v32, v32
    v_mfma_f32_32x32x16_bf16 v[34:49], v[58:61], v[90:93], v[34:49]
    v_mul_f32 v98, v98, v30
    v_mul_f32 v99, v99, v31
    v_cvt_pk_bf16_f32 v98, v98, v99
    v_mul_f32 v100, v100, v32
    v_add_f32 v33, 1.0, v33
    v_rcp_f32 v33, v33
    s_nop 0
    v_mul_f32 v101, v101, v33
    v_cvt_pk_bf16_f32 v99, v100, v101
    ds_write_b64 v4, v[98:99] offset:8
    v_exp_f32 v30, -v102
    v_exp_f32 v31, -v103
    v_exp_f32 v32, -v104
    v_exp_f32 v33, -v105
    v_pk_add_f32 v[30:31], v[30:31], 1.0 op_sel_hi:[1,0]
    v_pk_add_f32 v[32:33], v[32:33], 1.0 op_sel_hi:[1,0]
    v_rcp_f32 v30, v30
    v_rcp_f32 v31, v31
    v_rcp_f32 v32, v32
    v_rcp_f32 v33, v33
    v_pk_mul_f32 v[102:103], v[102:103], v[30:31]
    v_pk_mul_f32 v[104:105], v[104:105], v[32:33]
    v_cvt_pk_bf16_f32 v102, v102, v103
    v_cvt_pk_bf16_f32 v103, v104, v105
    ds_write_b64 v5, v[102:103] offset:0
    v_xor_b32 v4, 1024, v4
    v_xor_b32 v5, 1024, v5
    v_exp_f32 v30, -v106
    v_exp_f32 v31, -v107
    v_exp_f32 v32, -v108
    v_exp_f32 v33, -v109
    v_pk_add_f32 v[30:31], v[30:31], 1.0 op_sel_hi:[1,0]
    v_pk_add_f32 v[32:33], v[32:33], 1.0 op_sel_hi:[1,0]
    v_rcp_f32 v30, v30
    v_rcp_f32 v31, v31
    v_rcp_f32 v32, v32
    v_rcp_f32 v33, v33
    v_pk_mul_f32 v[106:107], v[106:107], v[30:31]
    v_pk_mul_f32 v[108:109], v[108:109], v[32:33]
    v_cvt_pk_bf16_f32 v106, v106, v107
    v_cvt_pk_bf16_f32 v107, v108, v109
    ds_write_b64 v6, v[106:107] offset:0
    ds_read_b64_tr_b16 v[110:111], v13 offset:0
    ds_read_b64_tr_b16 v[112:113], v13 offset:2048
    ds_read_b64_tr_b16 v[114:115], v127 offset:0
    ds_read_b64_tr_b16 v[116:117], v127 offset:2048
    v_pk_mul_f32 v[34:35], v[34:35], s[64:65]
    v_pk_mul_f32 v[36:37], v[36:37], s[64:65]
    v_pk_mul_f32 v[38:39], v[38:39], s[64:65]
    v_pk_mul_f32 v[40:41], v[40:41], s[64:65]
    v_cvt_pk_bf16_f32 v14, v34, v35
    v_cvt_pk_bf16_f32 v15, v36, v37
    v_cvt_pk_bf16_f32 v16, v38, v39
    v_cvt_pk_bf16_f32 v17, v40, v41
    s_mov_b32 vcc_lo, 0xaaaaaaaa
    s_mov_b32 vcc_hi, 0xaaaaaaaa
    v_cndmask_b32_dpp v24, v14, v16, vcc quad_perm:[1,0,3,2] row_mask:0xf bank_mask:0xf
    v_cndmask_b32_dpp v25, v15, v17, vcc quad_perm:[1,0,3,2] row_mask:0xf bank_mask:0xf
    s_not_b64 vcc, vcc
    v_cndmask_b32_dpp v22, v16, v14, vcc quad_perm:[1,0,3,2] row_mask:0xf bank_mask:0xf
    v_cndmask_b32_dpp v23, v17, v15, vcc quad_perm:[1,0,3,2] row_mask:0xf bank_mask:0xf
    s_waitcnt lgkmcnt(0)
    s_barrier
    ds_read_b128 v[118:121], v1 offset:32768
    ds_read_b128 v[42:45], v1 offset:34816
    ds_read_b128 v[46:49], v1 offset:33792
    ds_read_b128 v[50:53], v1 offset:35840
    s_waitcnt lgkmcnt(3)
    v_mfma_f32_16x16x32_bf16 v[62:65], v[128:131], v[118:121], 0
    s_waitcnt lgkmcnt(2)
    ds_read_b128 v[54:57], v1 offset:36864
    v_mfma_f32_16x16x32_bf16 v[62:65], v[110:113], v[42:45], v[62:65]
    s_waitcnt lgkmcnt(2)
    ds_read_b64_tr_b16 v[94:95], v13 offset:4096
    ds_read_b64_tr_b16 v[96:97], v13 offset:6144
    v_mfma_f32_16x16x32_bf16 v[70:73], v[128:131], v[46:49], 0
    s_waitcnt lgkmcnt(3)
    ds_read_b128 v[98:101], v1 offset:38912
    v_mfma_f32_16x16x32_bf16 v[70:73], v[110:113], v[50:53], v[70:73]
    ds_read_b128 v[102:105], v1 offset:37888
    v_mfma_f32_16x16x32_bf16 v[74:77], v[132:135], v[46:49], 0
    ds_read_b128 v[106:109], v1 offset:39936
    v_mfma_f32_16x16x32_bf16 v[74:77], v[114:117], v[50:53], v[74:77]
    ds_read_b64_tr_b16 v[34:35], v127 offset:4096
    ds_read_b64_tr_b16 v[36:37], v127 offset:6144
    v_mfma_f32_16x16x32_bf16 v[66:69], v[132:135], v[118:121], 0
    ds_read_b128 v[38:41], v1 offset:40960
    v_mfma_f32_16x16x32_bf16 v[66:69], v[114:117], v[42:45], v[66:69]
    s_waitcnt lgkmcnt(8)
    ds_read_b64_tr_b16 v[110:111], v13 offset:8192
    ds_read_b64_tr_b16 v[112:113], v13 offset:10240
    v_mfma_f32_16x16x32_bf16 v[62:65], v[136:139], v[54:57], v[62:65]
    s_waitcnt lgkmcnt(7)
    ds_read_b128 v[46:49], v1 offset:43008
    v_mfma_f32_16x16x32_bf16 v[62:65], v[94:97], v[98:101], v[62:65]
    s_waitcnt lgkmcnt(7)
    ds_read_b128 v[118:121], v1 offset:41984
    v_mfma_f32_16x16x32_bf16 v[70:73], v[136:139], v[102:105], v[70:73]
    s_waitcnt lgkmcnt(7)
    ds_read_b128 v[114:117], v1 offset:44032
    v_mfma_f32_16x16x32_bf16 v[70:73], v[94:97], v[106:109], v[70:73]
    ds_read_b64_tr_b16 v[94:95], v127 offset:8192
    ds_read_b64_tr_b16 v[96:97], v127 offset:10240
    v_mfma_f32_16x16x32_bf16 v[74:77], v[140:143], v[102:105], v[74:77]
    s_waitcnt lgkmcnt(8)
    buffer_load_dword v123, v3, s[32:35], s47 offen offset:256 sc1
    v_mfma_f32_16x16x32_bf16 v[74:77], v[34:37], v[106:109], v[74:77]
    ds_read_b128 v[102:105], v1 offset:45056
    v_mfma_f32_16x16x32_bf16 v[66:69], v[140:143], v[54:57], v[66:69]
    buffer_store_dwordx4 v[22:25], v10, s[20:23], 0 offen offset:0
    v_mfma_f32_16x16x32_bf16 v[66:69], v[34:37], v[98:101], v[66:69]
    s_waitcnt lgkmcnt(8)
    ds_read_b128 v[54:57], v1 offset:46080
    v_mfma_f32_16x16x32_bf16 v[62:65], v[144:147], v[38:41], v[62:65]
    s_waitcnt lgkmcnt(6)
    ds_read_b128 v[34:37], v1 offset:32768
    v_mfma_f32_16x16x32_bf16 v[62:65], v[110:113], v[46:49], v[62:65]
    s_waitcnt lgkmcnt(6)
    v_mfma_f32_16x16x32_bf16 v[70:73], v[144:147], v[118:121], v[70:73]
    s_waitcnt lgkmcnt(5)
    v_mfma_f32_16x16x32_bf16 v[70:73], v[110:113], v[114:117], v[70:73]
    ds_read_b64_tr_b16 v[110:111], v125 offset:0
    ds_read_b64_tr_b16 v[112:113], v125 offset:2048
    v_mfma_f32_16x16x32_bf16 v[74:77], v[148:151], v[118:121], v[74:77]
    s_waitcnt lgkmcnt(5)
    ds_read_b128 v[118:121], v1 offset:33792
    v_mfma_f32_16x16x32_bf16 v[74:77], v[94:97], v[114:117], v[74:77]
    v_mfma_f32_16x16x32_bf16 v[66:69], v[148:151], v[38:41], v[66:69]
    ds_read_b64_tr_b16 v[38:39], v122 offset:0
    ds_read_b64_tr_b16 v[40:41], v122 offset:2048
    v_mfma_f32_16x16x32_bf16 v[66:69], v[94:97], v[46:49], v[66:69]
    s_waitcnt lgkmcnt(7)
    ds_read_b128 v[94:97], v1 offset:36864
    v_mfma_f32_16x16x32_bf16 v[62:65], v[152:155], v[102:105], v[62:65]
    s_waitcnt lgkmcnt(7)
    v_mfma_f32_16x16x32_bf16 v[70:73], v[152:155], v[54:57], v[70:73]
    v_mfma_f32_16x16x32_bf16 v[74:77], v[156:159], v[54:57], v[74:77]
    ds_read_b64_tr_b16 v[54:55], v125 offset:4096
    ds_read_b64_tr_b16 v[56:57], v125 offset:6144
    v_mfma_f32_16x16x32_bf16 v[66:69], v[156:159], v[102:105], v[66:69]
    s_waitcnt lgkmcnt(8)
    ds_read_b128 v[102:105], v1 offset:37888
    v_mfma_f32_16x16x32_bf16 v[78:81], v[160:163], v[34:37], 0
    s_waitcnt lgkmcnt(7)
    v_mfma_f32_16x16x32_bf16 v[78:81], v[110:113], v[42:45], v[78:81]
    s_waitcnt lgkmcnt(6)
    v_mfma_f32_16x16x32_bf16 v[86:89], v[160:163], v[118:121], 0
    v_cvt_pk_bf16_f32 v70, v70, v71
    v_cvt_pk_bf16_f32 v71, v72, v73
    v_mfma_f32_16x16x32_bf16 v[86:89], v[110:113], v[50:53], v[86:89]
    ds_read_b64_tr_b16 v[110:111], v122 offset:4096
    ds_read_b64_tr_b16 v[112:113], v122 offset:6144
    v_mfma_f32_16x16x32_bf16 v[90:93], v[164:167], v[118:121], 0
    s_waitcnt lgkmcnt(6)
    ds_read_b128 v[118:121], v1 offset:40960
    v_cvt_pk_bf16_f32 v72, v74, v75
    v_mfma_f32_16x16x32_bf16 v[90:93], v[38:41], v[50:53], v[90:93]
    v_cvt_pk_bf16_f32 v73, v76, v77
    v_cvt_pk_bf16_f32 v62, v62, v63
    v_mfma_f32_16x16x32_bf16 v[82:85], v[164:167], v[34:37], 0
    ds_read_b64_tr_b16 v[34:35], v125 offset:8192
    ds_read_b64_tr_b16 v[36:37], v125 offset:10240
    v_mfma_f32_16x16x32_bf16 v[82:85], v[38:41], v[42:45], v[82:85]
    s_waitcnt lgkmcnt(8)
    ds_read_b128 v[38:41], v1 offset:41984
    v_cvt_pk_bf16_f32 v63, v64, v65
    v_mfma_f32_16x16x32_bf16 v[78:81], v[168:171], v[94:97], v[78:81]
    s_waitcnt vmcnt(1) lgkmcnt(7)
    v_cmp_ne_u32 vcc, s46, v123
    v_cvt_pk_bf16_f32 v64, v66, v67
    v_mfma_f32_16x16x32_bf16 v[78:81], v[54:57], v[98:101], v[78:81]
    s_waitcnt lgkmcnt(6)
    v_cvt_pk_bf16_f32 v65, v68, v69
    v_mfma_f32_16x16x32_bf16 v[86:89], v[168:171], v[102:105], v[86:89]
    s_cbranch_vccnz L4_wait8
L4_got8:
    v_mfma_f32_16x16x32_bf16 v[86:89], v[54:57], v[106:109], v[86:89]
    ds_read_b64_tr_b16 v[54:55], v122 offset:8192
    ds_read_b64_tr_b16 v[56:57], v122 offset:10240
    v_mfma_f32_16x16x32_bf16 v[90:93], v[172:175], v[102:105], v[90:93]
    s_waitcnt lgkmcnt(6)
    buffer_store_dwordx4 v[70:73], v7, s[32:35], s53 offen offset:0
    v_mfma_f32_16x16x32_bf16 v[90:93], v[110:113], v[106:109], v[90:93]
    ds_read_b128 v[102:105], v1 offset:45056
    v_mfma_f32_16x16x32_bf16 v[82:85], v[172:175], v[94:97], v[82:85]
    ds_read_b128 v[94:97], v1 offset:46080
    v_mfma_f32_16x16x32_bf16 v[82:85], v[110:113], v[98:101], v[82:85]
    s_waitcnt lgkmcnt(7)
    ds_read_b128 v[110:113], v1 offset:32768
    v_mfma_f32_16x16x32_bf16 v[78:81], v[176:179], v[118:121], v[78:81]
    s_waitcnt lgkmcnt(6)
    v_mfma_f32_16x16x32_bf16 v[78:81], v[34:37], v[46:49], v[78:81]
    s_waitcnt lgkmcnt(5)
    v_mfma_f32_16x16x32_bf16 v[86:89], v[176:179], v[38:41], v[86:89]
    v_mfma_f32_16x16x32_bf16 v[86:89], v[34:37], v[114:117], v[86:89]
    ds_read_b64_tr_b16 v[34:35], v13 offset:12288
    ds_read_b64_tr_b16 v[36:37], v13 offset:14336
    v_mfma_f32_16x16x32_bf16 v[90:93], v[180:183], v[38:41], v[90:93]
    s_waitcnt lgkmcnt(5)
    ds_read_b128 v[38:41], v1 offset:33792
    v_mfma_f32_16x16x32_bf16 v[90:93], v[54:57], v[114:117], v[90:93]
    v_mfma_f32_16x16x32_bf16 v[82:85], v[180:183], v[118:121], v[82:85]
    buffer_store_dwordx4 v[62:65], v7, s[32:35], s52 offen offset:0
    v_mfma_f32_16x16x32_bf16 v[82:85], v[54:57], v[46:49], v[82:85]
    s_waitcnt lgkmcnt(5)
    ds_read_b64_tr_b16 v[118:119], v127 offset:12288
    ds_read_b64_tr_b16 v[120:121], v127 offset:14336
    v_mfma_f32_16x16x32_bf16 v[78:81], v[184:187], v[102:105], v[78:81]
    s_waitcnt lgkmcnt(6)
    ds_read_b128 v[54:57], v1 offset:36864
    v_mfma_f32_16x16x32_bf16 v[86:89], v[184:187], v[94:97], v[86:89]
    v_mfma_f32_16x16x32_bf16 v[90:93], v[188:191], v[94:97], v[90:93]
    ds_read_b64_tr_b16 v[94:95], v13 offset:16384
    ds_read_b64_tr_b16 v[96:97], v13 offset:18432
    v_mfma_f32_16x16x32_bf16 v[82:85], v[188:191], v[102:105], v[82:85]
    s_waitcnt lgkmcnt(8)
    ds_read_b128 v[102:105], v1 offset:37888
    v_mfma_f32_16x16x32_bf16 v[62:65], v[192:195], v[110:113], 0
    s_waitcnt lgkmcnt(7)
    v_mfma_f32_16x16x32_bf16 v[62:65], v[34:37], v[42:45], v[62:65]
    s_waitcnt lgkmcnt(6)
    v_mfma_f32_16x16x32_bf16 v[70:73], v[192:195], v[38:41], 0
    v_cvt_pk_bf16_f32 v86, v86, v87
    v_cvt_pk_bf16_f32 v87, v88, v89
    v_mfma_f32_16x16x32_bf16 v[70:73], v[34:37], v[50:53], v[70:73]
    ds_read_b64_tr_b16 v[34:35], v127 offset:16384
    ds_read_b64_tr_b16 v[36:37], v127 offset:18432
    v_mfma_f32_16x16x32_bf16 v[74:77], v[196:199], v[38:41], 0
    s_waitcnt lgkmcnt(6)
    ds_read_b128 v[38:41], v1 offset:40960
    v_cvt_pk_bf16_f32 v88, v90, v91
    v_mfma_f32_16x16x32_bf16 v[74:77], v[118:121], v[50:53], v[74:77]
    v_cvt_pk_bf16_f32 v89, v92, v93
    v_cvt_pk_bf16_f32 v78, v78, v79
    v_mfma_f32_16x16x32_bf16 v[66:69], v[196:199], v[110:113], 0
    ds_read_b64_tr_b16 v[110:111], v13 offset:20480
    ds_read_b64_tr_b16 v[112:113], v13 offset:22528
    v_mfma_f32_16x16x32_bf16 v[66:69], v[118:121], v[42:45], v[66:69]
    s_waitcnt lgkmcnt(8)
    ds_read_b128 v[118:121], v1 offset:41984
    v_cvt_pk_bf16_f32 v79, v80, v81
    v_mfma_f32_16x16x32_bf16 v[62:65], v[200:203], v[54:57], v[62:65]
    s_waitcnt lgkmcnt(7)
    v_cvt_pk_bf16_f32 v80, v82, v83
    v_cvt_pk_bf16_f32 v81, v84, v85
    v_mfma_f32_16x16x32_bf16 v[62:65], v[94:97], v[98:101], v[62:65]
    s_waitcnt lgkmcnt(6)
    v_mfma_f32_16x16x32_bf16 v[70:73], v[200:203], v[102:105], v[70:73]
    v_mfma_f32_16x16x32_bf16 v[70:73], v[94:97], v[106:109], v[70:73]
    ds_read_b64_tr_b16 v[94:95], v127 offset:20480
    ds_read_b64_tr_b16 v[96:97], v127 offset:22528
    v_mfma_f32_16x16x32_bf16 v[74:77], v[204:207], v[102:105], v[74:77]
    s_waitcnt lgkmcnt(6)
    buffer_store_dwordx4 v[86:89], v7, s[32:35], s53 offen offset:256
    v_mfma_f32_16x16x32_bf16 v[74:77], v[34:37], v[106:109], v[74:77]
    ds_read_b128 v[102:105], v1 offset:45056
    v_mfma_f32_16x16x32_bf16 v[66:69], v[204:207], v[54:57], v[66:69]
    ds_read_b128 v[54:57], v1 offset:46080
    v_mfma_f32_16x16x32_bf16 v[66:69], v[34:37], v[98:101], v[66:69]
    s_waitcnt lgkmcnt(7)
    ds_read_b128 v[34:37], v1 offset:32768
    v_mfma_f32_16x16x32_bf16 v[62:65], v[208:211], v[38:41], v[62:65]
    s_waitcnt lgkmcnt(6)
    v_mfma_f32_16x16x32_bf16 v[62:65], v[110:113], v[46:49], v[62:65]
    s_waitcnt lgkmcnt(5)
    v_mfma_f32_16x16x32_bf16 v[70:73], v[208:211], v[118:121], v[70:73]
    v_mfma_f32_16x16x32_bf16 v[70:73], v[110:113], v[114:117], v[70:73]
    ds_read_b64_tr_b16 v[110:111], v125 offset:12288
    ds_read_b64_tr_b16 v[112:113], v125 offset:14336
    v_mfma_f32_16x16x32_bf16 v[74:77], v[212:215], v[118:121], v[74:77]
    s_waitcnt lgkmcnt(5)
    ds_read_b128 v[118:121], v1 offset:33792
    v_mfma_f32_16x16x32_bf16 v[74:77], v[94:97], v[114:117], v[74:77]
    v_mfma_f32_16x16x32_bf16 v[66:69], v[212:215], v[38:41], v[66:69]
    buffer_store_dwordx4 v[78:81], v7, s[32:35], s52 offen offset:256
    v_mfma_f32_16x16x32_bf16 v[66:69], v[94:97], v[46:49], v[66:69]
    s_waitcnt lgkmcnt(5)
    ds_read_b64_tr_b16 v[38:39], v122 offset:12288
    ds_read_b64_tr_b16 v[40:41], v122 offset:14336
    v_mfma_f32_16x16x32_bf16 v[62:65], v[216:219], v[102:105], v[62:65]
    s_waitcnt lgkmcnt(6)
    ds_read_b128 v[94:97], v1 offset:36864
    v_mfma_f32_16x16x32_bf16 v[70:73], v[216:219], v[54:57], v[70:73]
    v_mfma_f32_16x16x32_bf16 v[74:77], v[220:223], v[54:57], v[74:77]
    ds_read_b64_tr_b16 v[54:55], v125 offset:16384
    ds_read_b64_tr_b16 v[56:57], v125 offset:18432
    v_mfma_f32_16x16x32_bf16 v[66:69], v[220:223], v[102:105], v[66:69]
    s_waitcnt lgkmcnt(8)
    ds_read_b128 v[102:105], v1 offset:37888
    v_mfma_f32_16x16x32_bf16 v[78:81], v[224:227], v[34:37], 0
    s_waitcnt lgkmcnt(7)
    v_mfma_f32_16x16x32_bf16 v[78:81], v[110:113], v[42:45], v[78:81]
    s_waitcnt lgkmcnt(6)
    v_mfma_f32_16x16x32_bf16 v[86:89], v[224:227], v[118:121], 0
    v_cvt_pk_bf16_f32 v70, v70, v71
    v_cvt_pk_bf16_f32 v71, v72, v73
    v_mfma_f32_16x16x32_bf16 v[86:89], v[110:113], v[50:53], v[86:89]
    ds_read_b64_tr_b16 v[110:111], v122 offset:16384
    ds_read_b64_tr_b16 v[112:113], v122 offset:18432
    v_mfma_f32_16x16x32_bf16 v[90:93], v[228:231], v[118:121], 0
LP_6:
    s_cbranch_execz LP_7
    s_waitcnt lgkmcnt(6)
    ds_read_b128 v[118:121], v1 offset:40960
    v_cvt_pk_bf16_f32 v72, v74, v75
    v_mfma_f32_16x16x32_bf16 v[90:93], v[38:41], v[50:53], v[90:93]
    ds_read_b64_tr_b16 v[50:51], v125 offset:20480
    ds_read_b64_tr_b16 v[52:53], v125 offset:22528
    v_mfma_f32_16x16x32_bf16 v[82:85], v[228:231], v[34:37], 0
    ds_read_b128 v[34:37], v1 offset:41984
    v_cvt_pk_bf16_f32 v73, v76, v77
    v_mfma_f32_16x16x32_bf16 v[82:85], v[38:41], v[42:45], v[82:85]
    s_waitcnt lgkmcnt(9)
    ds_read_b64_tr_b16 v[38:39], v122 offset:20480
    ds_read_b64_tr_b16 v[40:41], v122 offset:22528
    v_mfma_f32_16x16x32_bf16 v[78:81], v[232:235], v[94:97], v[78:81]
    s_waitcnt lgkmcnt(9)
    ds_read_b128 v[42:45], v1 offset:45056
    v_cvt_pk_bf16_f32 v62, v62, v63
    v_mfma_f32_16x16x32_bf16 v[78:81], v[54:57], v[98:101], v[78:81]
    s_waitcnt lgkmcnt(9)
    v_cvt_pk_bf16_f32 v63, v64, v65
    v_cvt_pk_bf16_f32 v64, v66, v67
    v_mfma_f32_16x16x32_bf16 v[86:89], v[232:235], v[102:105], v[86:89]
    v_cvt_pk_bf16_f32 v65, v68, v69
    v_mfma_f32_16x16x32_bf16 v[86:89], v[54:57], v[106:109], v[86:89]
    ds_read_b128 v[54:57], v1 offset:46080
    v_mfma_f32_16x16x32_bf16 v[90:93], v[236:239], v[102:105], v[90:93]
    s_waitcnt lgkmcnt(8)
    buffer_store_dwordx4 v[70:73], v7, s[32:35], s53 offen offset:512
    v_mfma_f32_16x16x32_bf16 v[90:93], v[110:113], v[106:109], v[90:93]
    v_mfma_f32_16x16x32_bf16 v[82:85], v[236:239], v[94:97], v[82:85]
    v_mfma_f32_16x16x32_bf16 v[82:85], v[110:113], v[98:101], v[82:85]
    s_waitcnt lgkmcnt(7)
    v_mfma_f32_16x16x32_bf16 v[78:81], v[240:243], v[118:121], v[78:81]
    s_waitcnt lgkmcnt(5)
    v_mfma_f32_16x16x32_bf16 v[78:81], v[50:53], v[46:49], v[78:81]
    s_waitcnt lgkmcnt(4)
    v_mfma_f32_16x16x32_bf16 v[86:89], v[240:243], v[34:37], v[86:89]
    v_mfma_f32_16x16x32_bf16 v[86:89], v[50:53], v[114:117], v[86:89]
    v_mfma_f32_16x16x32_bf16 v[90:93], v[244:247], v[34:37], v[90:93]
    s_waitcnt lgkmcnt(2)
    v_mfma_f32_16x16x32_bf16 v[90:93], v[38:41], v[114:117], v[90:93]
    v_mfma_f32_16x16x32_bf16 v[82:85], v[244:247], v[118:121], v[82:85]
    buffer_store_dwordx4 v[62:65], v7, s[32:35], s52 offen offset:512
    v_mfma_f32_16x16x32_bf16 v[82:85], v[38:41], v[46:49], v[82:85]
    s_waitcnt lgkmcnt(1)
    v_mfma_f32_16x16x32_bf16 v[78:81], v[248:251], v[42:45], v[78:81]
    s_waitcnt lgkmcnt(0)
    v_mfma_f32_16x16x32_bf16 v[86:89], v[248:251], v[54:57], v[86:89]
    v_mfma_f32_16x16x32_bf16 v[90:93], v[252:255], v[54:57], v[90:93]
    v_mfma_f32_16x16x32_bf16 v[82:85], v[252:255], v[42:45], v[82:85]
    s_nop 5
    v_cvt_pk_bf16_f32 v86, v86, v87
    v_cvt_pk_bf16_f32 v87, v88, v89
    v_cvt_pk_bf16_f32 v88, v90, v91
    v_cvt_pk_bf16_f32 v89, v92, v93
    buffer_store_dwordx4 v[86:89], v124, s[32:35], s26 offen
    v_cvt_pk_bf16_f32 v78, v78, v79
    v_cvt_pk_bf16_f32 v79, v80, v81
    v_cvt_pk_bf16_f32 v80, v82, v83
    v_cvt_pk_bf16_f32 v81, v84, v85
    buffer_store_dwordx4 v[78:81], v124, s[32:35], s81 offen
    v_and_b32 v122, 4, v3
    s_waitcnt vmcnt(0)
    buffer_store_byte v0, off, s[32:35], s44 offset:288
    s_cmp_lg_u32 s48, 0
    s_cselect_b32 s49, 1, 200
L4_spin9:
    buffer_load_dword v123, v122, s[32:35], s45 offen offset:288 sc1
    s_sub_u32 s49, s49, 1
    s_cbranch_scc1 L4_slow9
    s_waitcnt vmcnt(0)
    v_cmp_ne_u32 vcc, s46, v123
    s_cbranch_vccnz L4_spin9
L4_got9:
    buffer_load_dwordx4 v[62:65], v8, s[32:35], s88 offen sc1
    buffer_load_dwordx4 v[66:69], v8, s[32:35], s89 offen sc1
    buffer_load_dwordx4 v[70:73], v8, s[32:35], s90 offen sc1
    buffer_load_dwordx4 v[74:77], v8, s[32:35], s91 offen sc1
    buffer_load_dwordx4 v[78:81], v8, s[32:35], s92 offen sc1
    buffer_load_dwordx4 v[82:85], v8, s[32:35], s93 offen sc1
    buffer_load_dwordx4 v[86:89], v8, s[32:35], s94 offen sc1
    buffer_load_dwordx4 v[90:93], v8, s[32:35], s95 offen sc1
    v_mfma_f32_32x32x16_bf16 v[34:49], v[58:61], v[18:21], 0
    s_waitcnt vmcnt(7)
    v_mfma_f32_32x32x16_bf16 v[34:49], v[58:61], v[62:65], v[34:49]
    s_waitcnt vmcnt(6)
    v_mfma_f32_32x32x16_bf16 v[34:49], v[58:61], v[66:69], v[34:49]
    s_waitcnt vmcnt(5)
    v_mfma_f32_32x32x16_bf16 v[34:49], v[58:61], v[70:73], v[34:49]
    s_waitcnt vmcnt(4)
    v_mfma_f32_32x32x16_bf16 v[34:49], v[58:61], v[74:77], v[34:49]
    s_waitcnt vmcnt(3)
    v_mfma_f32_32x32x16_bf16 v[34:49], v[58:61], v[78:81], v[34:49]
    s_waitcnt vmcnt(2)
    v_mfma_f32_32x32x16_bf16 v[34:49], v[58:61], v[82:85], v[34:49]
    s_waitcnt vmcnt(1)
    v_mfma_f32_32x32x16_bf16 v[34:49], v[58:61], v[86:89], v[34:49]
    s_waitcnt vmcnt(0)
    v_mfma_f32_32x32x16_bf16 v[34:49], v[58:61], v[90:93], v[34:49]
    s_nop 11
    v_pk_mul_f32 v[34:35], v[34:35], s[64:65]
    v_pk_mul_f32 v[36:37], v[36:37], s[64:65]
    v_pk_mul_f32 v[38:39], v[38:39], s[64:65]
    v_pk_mul_f32 v[40:41], v[40:41], s[64:65]
    v_cvt_pk_bf16_f32 v18, v34, v35
    v_cvt_pk_bf16_f32 v19, v36, v37
    v_cvt_pk_bf16_f32 v20, v38, v39
    v_cvt_pk_bf16_f32 v21, v40, v41
    s_mov_b32 vcc_lo, 0xaaaaaaaa
    s_mov_b32 vcc_hi, 0xaaaaaaaa
    v_cndmask_b32_dpp v28, v18, v20, vcc quad_perm:[1,0,3,2] row_mask:0xf bank_mask:0xf
    v_cndmask_b32_dpp v29, v19, v21, vcc quad_perm:[1,0,3,2] row_mask:0xf bank_mask:0xf
    s_not_b64 vcc, vcc
    v_cndmask_b32_dpp v26, v20, v18, vcc quad_perm:[1,0,3,2] row_mask:0xf bank_mask:0xf
    v_cndmask_b32_dpp v27, v21, v19, vcc quad_perm:[1,0,3,2] row_mask:0xf bank_mask:0xf
    buffer_store_dwordx4 v[26:29], v10, s[20:23], 0 offen offset:1024
L2_end:
    s_endpgm
L5_wait2:
    s_cmp_lg_u32 s48, 0
    s_cbranch_scc1 L5_got2
    s_mov_b32 s49, 400000
L5_poll2:
    buffer_load_dword v123, v118, s[32:35], s24 offen offset:2048 sc1
    s_waitcnt vmcnt(0)
    s_sub_u32 s49, s49, 1
    s_cbranch_scc1 L5_got2
    v_cmp_ne_u32 vcc, s46, v123
    s_cbranch_vccnz L5_poll2
    s_branch L5_got2
L5_rdywait:
    s_movk_i32 s49, 200
L5_rdyloop:
    buffer_load_ubyte v123, off, s[28:31], s36 sc1
    s_waitcnt vmcnt(0)
    v_cmp_ne_u32 vcc, s41, v123
    s_cbranch_vccz L5_rdy
    s_sub_u32 s49, s49, 1
    s_cbranch_scc0 L5_rdyloop
    s_mov_b32 s48, 2
    s_branch L5_rdyskip
L5_wait0:
    s_movk_i32 s49, 200
L5_poll0:
    buffer_load_dword v123, v118, s[32:35], s86 offen offset:2048 sc1
    s_sub_u32 s49, s49, 1
    s_cbranch_scc1 L5_slow0
    s_waitcnt vmcnt(0)
    v_cmp_ne_u32 vcc, s46, v123
    s_cbranch_vccnz L5_poll0
    s_branch L5_got0
L5_slow0:
    s_waitcnt vmcnt(0)
    buffer_wbl2 sc1
    s_waitcnt vmcnt(0)
    s_lshl_b32 s74, s36, 2
    s_mov_b64 exec, 1
    buffer_atomic_add v121, off, s[28:31], s74 offset:160 sc1
    s_mov_b64 exec, -1
    s_mov_b32 s49, 200000
L5_spoll0:
    s_waitcnt vmcnt(0)
    s_cmp_eq_u32 s48, 2
    s_cbranch_scc1 L5_nofast0
    buffer_load_dword v123, v118, s[32:35], s86 offen offset:2048 sc1
    s_waitcnt vmcnt(0)
    v_cmp_ne_u32 vcc, s46, v123
    s_cbranch_vccz L5_got0
L5_nofast0:
    buffer_load_dword v123, off, s[28:31], s74 offset:160 sc1
    s_sub_u32 s49, s49, 1
    s_cbranch_scc1 L5_sgot0
    s_waitcnt vmcnt(0)
    v_cmp_ne_u32 vcc, 0x80, v123
    s_cbranch_vccnz L5_spoll0
L5_sgot0:
    s_mov_b32 s48, 1
    s_waitcnt vmcnt(0)
    buffer_inv sc1
    s_waitcnt vmcnt(0)
    s_branch L5_got0
L5_rwait:
    s_mov_b32 s49, 400000
L5_rloop:
    buffer_load_dword v123, v3, s[28:31], 0 offen offset:128 sc1
    s_waitcnt vmcnt(0)
    s_sub_u32 s49, s49, 1
    s_cbranch_scc1 L5_rgot
    v_cmp_ne_u32 vcc, 1, v123
    s_cbranch_vccnz L5_rloop
    s_branch L5_rgot
L4_wait0:
    s_cmp_lg_u32 s48, 0
    s_cbranch_scc1 L4_slow0
    s_movk_i32 s49, 200
L4_poll0:
    buffer_load_dword v123, v3, s[32:35], s47 offen offset:0 sc1
    s_sub_u32 s49, s49, 1
    s_cbranch_scc1 L4_slow0
    s_waitcnt vmcnt(0)
    v_cmp_ne_u32 vcc, s46, v123
    s_cbranch_vccnz L4_poll0
    s_branch L4_got0
L4_slow0:
    s_waitcnt vmcnt(0)
    buffer_wbl2 sc1
    s_waitcnt vmcnt(0)
    v_mov_b32 v123, 1
    s_add_u32 s74, s44, 32768
    s_add_u32 s75, s47, 32768
    buffer_store_byte v123, off, s[32:35], s74 offset:0 sc1
    s_mov_b32 s49, 200000
L4_spoll0:
    s_waitcnt vmcnt(0)
    buffer_load_dword v123, v3, s[32:35], s47 offen offset:0 sc1
    s_waitcnt vmcnt(0)
    v_cmp_ne_u32 vcc, s46, v123
    s_cbranch_vccz L4_got0
    buffer_load_dword v123, v3, s[32:35], s75 offen offset:0 sc1
    s_sub_u32 s49, s49, 1
    s_cbranch_scc1 L4_sgot0
    s_waitcnt vmcnt(0)
    v_cmp_ne_u32 vcc, s72, v123
    s_cbranch_vccnz L4_spoll0
L4_sgot0:
    s_mov_b32 s48, 1
    s_waitcnt vmcnt(0)
    buffer_inv sc1
    s_waitcnt vmcnt(0)
    s_branch L4_got0
L4_wait1:
    s_cmp_lg_u32 s48, 0
    s_cbranch_scc1 L4_slow1
    s_movk_i32 s49, 200
L4_poll1:
    buffer_load_dword v123, v3, s[32:35], s47 offen offset:32 sc1
    s_sub_u32 s49, s49, 1
    s_cbranch_scc1 L4_slow1
    s_waitcnt vmcnt(0)
    v_cmp_ne_u32 vcc, s46, v123
    s_cbranch_vccnz L4_poll1
    s_branch L4_got1
L4_slow1:
    s_waitcnt vmcnt(0)
    buffer_wbl2 sc1
    s_waitcnt vmcnt(0)
    v_mov_b32 v123, 1
    s_add_u32 s74, s44, 32768
    s_add_u32 s75, s47, 32768
    buffer_store_byte v123, off, s[32:35], s74 offset:32 sc1
    s_mov_b32 s49, 200000
L4_spoll1:
    s_waitcnt vmcnt(0)
    buffer_load_dword v123, v3, s[32:35], s47 offen offset:32 sc1
    s_waitcnt vmcnt(0)
    v_cmp_ne_u32 vcc, s46, v123
    s_cbranch_vccz L4_got1
    buffer_load_dword v123, v3, s[32:35], s75 offen offset:32 sc1
    s_sub_u32 s49, s49, 1
    s_cbranch_scc1 L4_sgot1
    s_waitcnt vmcnt(0)
    v_cmp_ne_u32 vcc, s72, v123
    s_cbranch_vccnz L4_spoll1
L4_sgot1:
    s_mov_b32 s48, 1
    s_waitcnt vmcnt(0)
    buffer_inv sc1
    s_waitcnt vmcnt(0)
    s_branch L4_got1
L4_wait2:
    s_cmp_lg_u32 s48, 0
    s_cbranch_scc1 L4_slow2
    s_movk_i32 s49, 200
L4_poll2:
    buffer_load_dword v123, v3, s[32:35], s47 offen offset:64 sc1
    s_sub_u32 s49, s49, 1
    s_cbranch_scc1 L4_slow2
    s_waitcnt vmcnt(0)
    v_cmp_ne_u32 vcc, s46, v123
    s_cbranch_vccnz L4_poll2
    s_branch L4_got2
L4_slow2:
    s_waitcnt vmcnt(0)
    buffer_wbl2 sc1
    s_waitcnt vmcnt(0)
    v_mov_b32 v123, 1
    s_add_u32 s74, s44, 32768
    s_add_u32 s75, s47, 32768
    buffer_store_byte v123, off, s[32:35], s74 offset:64 sc1
    s_mov_b32 s49, 200000
L4_spoll2:
    s_waitcnt vmcnt(0)
    buffer_load_dword v123, v3, s[32:35], s47 offen offset:64 sc1
    s_waitcnt vmcnt(0)
    v_cmp_ne_u32 vcc, s46, v123
    s_cbranch_vccz L4_got2
    buffer_load_dword v123, v3, s[32:35], s75 offen offset:64 sc1
    s_sub_u32 s49, s49, 1
    s_cbranch_scc1 L4_sgot2
    s_waitcnt vmcnt(0)
    v_cmp_ne_u32 vcc, s72, v123
    s_cbranch_vccnz L4_spoll2
L4_sgot2:
    s_mov_b32 s48, 1
    s_waitcnt vmcnt(0)
    buffer_inv sc1
    s_waitcnt vmcnt(0)
    s_branch L4_got2
L4_wait3:
    s_cmp_lg_u32 s48, 0
    s_cbranch_scc1 L4_slow3
    s_movk_i32 s49, 200
L4_poll3:
    buffer_load_dword v123, v3, s[32:35], s47 offen offset:96 sc1
    s_sub_u32 s49, s49, 1
    s_cbranch_scc1 L4_slow3
    s_waitcnt vmcnt(0)
    v_cmp_ne_u32 vcc, s46, v123
    s_cbranch_vccnz L4_poll3
    s_branch L4_got3
L4_slow3:
    s_waitcnt vmcnt(0)
    buffer_wbl2 sc1
    s_waitcnt vmcnt(0)
    v_mov_b32 v123, 1
    s_add_u32 s74, s44, 32768
    s_add_u32 s75, s47, 32768
    buffer_store_byte v123, off, s[32:35], s74 offset:96 sc1
    s_mov_b32 s49, 200000
L4_spoll3:
    s_waitcnt vmcnt(0)
    buffer_load_dword v123, v3, s[32:35], s47 offen offset:96 sc1
    s_waitcnt vmcnt(0)
    v_cmp_ne_u32 vcc, s46, v123
    s_cbranch_vccz L4_got3
    buffer_load_dword v123, v3, s[32:35], s75 offen offset:96 sc1
    s_sub_u32 s49, s49, 1
    s_cbranch_scc1 L4_sgot3
    s_waitcnt vmcnt(0)
    v_cmp_ne_u32 vcc, s72, v123
    s_cbranch_vccnz L4_spoll3
L4_sgot3:
    s_mov_b32 s48, 1
    s_waitcnt vmcnt(0)
    buffer_inv sc1
    s_waitcnt vmcnt(0)
    s_branch L4_got3
L4_wait4:
    s_cmp_lg_u32 s48, 0
    s_cbranch_scc1 L4_slow4
    s_movk_i32 s49, 200
L4_poll4:
    buffer_load_dword v123, v3, s[32:35], s47 offen offset:128 sc1
    s_sub_u32 s49, s49, 1
    s_cbranch_scc1 L4_slow4
    s_waitcnt vmcnt(0)
    v_cmp_ne_u32 vcc, s46, v123
    s_cbranch_vccnz L4_poll4
    s_branch L4_got4
L4_slow4:
    s_waitcnt vmcnt(0)
    buffer_wbl2 sc1
    s_waitcnt vmcnt(0)
    v_mov_b32 v123, 1
    s_add_u32 s74, s44, 32768
    s_add_u32 s75, s47, 32768
    buffer_store_byte v123, off, s[32:35], s74 offset:128 sc1
    s_mov_b32 s49, 200000
L4_spoll4:
    s_waitcnt vmcnt(0)
    buffer_load_dword v123, v3, s[32:35], s47 offen offset:128 sc1
    s_waitcnt vmcnt(0)
    v_cmp_ne_u32 vcc, s46, v123
    s_cbranch_vccz L4_got4
    buffer_load_dword v123, v3, s[32:35], s75 offen offset:128 sc1
    s_sub_u32 s49, s49, 1
    s_cbranch_scc1 L4_sgot4
    s_waitcnt vmcnt(0)
    v_cmp_ne_u32 vcc, s72, v123
    s_cbranch_vccnz L4_spoll4
L4_sgot4:
    s_mov_b32 s48, 1
    s_waitcnt vmcnt(0)
    buffer_inv sc1
    s_waitcnt vmcnt(0)
    s_branch L4_got4
L4_wait5:
    s_cmp_lg_u32 s48, 0
    s_cbranch_scc1 L4_slow5
    s_movk_i32 s49, 200
L4_poll5:
    buffer_load_dword v123, v3, s[32:35], s47 offen offset:160 sc1
    s_sub_u32 s49, s49, 1
    s_cbranch_scc1 L4_slow5
    s_waitcnt vmcnt(0)
    v_cmp_ne_u32 vcc, s46, v123
    s_cbranch_vccnz L4_poll5
    s_branch L4_got5
L4_slow5:
    s_waitcnt vmcnt(0)
    buffer_wbl2 sc1
    s_waitcnt vmcnt(0)
    v_mov_b32 v123, 1
    s_add_u32 s74, s44, 32768
    s_add_u32 s75, s47, 32768
    buffer_store_byte v123, off, s[32:35], s74 offset:160 sc1
    s_mov_b32 s49, 200000
L4_spoll5:
    s_waitcnt vmcnt(0)
    buffer_load_dword v123, v3, s[32:35], s47 offen offset:160 sc1
    s_waitcnt vmcnt(0)
    v_cmp_ne_u32 vcc, s46, v123
    s_cbranch_vccz L4_got5
    buffer_load_dword v123, v3, s[32:35], s75 offen offset:160 sc1
    s_sub_u32 s49, s49, 1
    s_cbranch_scc1 L4_sgot5
    s_waitcnt vmcnt(0)
    v_cmp_ne_u32 vcc, s72, v123
    s_cbranch_vccnz L4_spoll5
L4_sgot5:
    s_mov_b32 s48, 1
    s_waitcnt vmcnt(0)
    buffer_inv sc1
    s_waitcnt vmcnt(0)
    s_branch L4_got5
L4_wait6:
    s_cmp_lg_u32 s48, 0
    s_cbranch_scc1 L4_slow6
    s_movk_i32 s49, 200
L4_poll6:
    buffer_load_dword v123, v3, s[32:35], s47 offen offset:192 sc1
    s_sub_u32 s49, s49, 1
    s_cbranch_scc1 L4_slow6
    s_waitcnt vmcnt(0)
    v_cmp_ne_u32 vcc, s46, v123
    s_cbranch_vccnz L4_poll6
    s_branch L4_got6
L4_slow6:
    s_waitcnt vmcnt(0)
    buffer_wbl2 sc1
    s_waitcnt vmcnt(0)
    v_mov_b32 v123, 1
    s_add_u32 s74, s44, 32768
    s_add_u32 s75, s47, 32768
    buffer_store_byte v123, off, s[32:35], s74 offset:192 sc1
    s_mov_b32 s49, 200000
L4_spoll6:
    s_waitcnt vmcnt(0)
    buffer_load_dword v123, v3, s[32:35], s47 offen offset:192 sc1
    s_waitcnt vmcnt(0)
    v_cmp_ne_u32 vcc, s46, v123
    s_cbranch_vccz L4_got6
    buffer_load_dword v123, v3, s[32:35], s75 offen offset:192 sc1
    s_sub_u32 s49, s49, 1
    s_cbranch_scc1 L4_sgot6
    s_waitcnt vmcnt(0)
    v_cmp_ne_u32 vcc, s72, v123
    s_cbranch_vccnz L4_spoll6
L4_sgot6:
    s_mov_b32 s48, 1
    s_waitcnt vmcnt(0)
    buffer_inv sc1
    s_waitcnt vmcnt(0)
    s_branch L4_got6
L4_wait7:
    s_cmp_lg_u32 s48, 0
    s_cbranch_scc1 L4_slow7
    s_movk_i32 s49, 200
L4_poll7:
    buffer_load_dword v123, v3, s[32:35], s47 offen offset:224 sc1
    s_sub_u32 s49, s49, 1
    s_cbranch_scc1 L4_slow7
    s_waitcnt vmcnt(0)
    v_cmp_ne_u32 vcc, s46, v123
    s_cbranch_vccnz L4_poll7
    s_branch L4_got7
L4_slow7:
    s_waitcnt vmcnt(0)
    buffer_wbl2 sc1
    s_waitcnt vmcnt(0)
    v_mov_b32 v123, 1
    s_add_u32 s74, s44, 32768
    s_add_u32 s75, s47, 32768
    buffer_store_byte v123, off, s[32:35], s74 offset:224 sc1
    s_mov_b32 s49, 200000
L4_spoll7:
    s_waitcnt vmcnt(0)
    buffer_load_dword v123, v3, s[32:35], s47 offen offset:224 sc1
    s_waitcnt vmcnt(0)
    v_cmp_ne_u32 vcc, s46, v123
    s_cbranch_vccz L4_got7
    buffer_load_dword v123, v3, s[32:35], s75 offen offset:224 sc1
    s_sub_u32 s49, s49, 1
    s_cbranch_scc1 L4_sgot7
    s_waitcnt vmcnt(0)
    v_cmp_ne_u32 vcc, s72, v123
    s_cbranch_vccnz L4_spoll7
L4_sgot7:
    s_mov_b32 s48, 1
    s_waitcnt vmcnt(0)
    buffer_inv sc1
    s_waitcnt vmcnt(0)
    s_branch L4_got7
L4_wait8:
    s_cmp_lg_u32 s48, 0
    s_cbranch_scc1 L4_slow8
    s_movk_i32 s49, 200
L4_poll8:
    buffer_load_dword v123, v3, s[32:35], s47 offen offset:256 sc1
    s_sub_u32 s49, s49, 1
    s_cbranch_scc1 L4_slow8
    s_waitcnt vmcnt(0)
    v_cmp_ne_u32 vcc, s46, v123
    s_cbranch_vccnz L4_poll8
    s_branch L4_got8
L4_slow8:
    s_waitcnt vmcnt(0)
    buffer_wbl2 sc1
    s_waitcnt vmcnt(0)
    v_mov_b32 v123, 1
    s_add_u32 s74, s44, 32768
    s_add_u32 s75, s47, 32768
    buffer_store_byte v123, off, s[32:35], s74 offset:256 sc1
    s_mov_b32 s49, 200000
L4_spoll8:
    s_waitcnt vmcnt(0)
    buffer_load_dword v123, v3, s[32:35], s47 offen offset:256 sc1
    s_waitcnt vmcnt(0)
    v_cmp_ne_u32 vcc, s46, v123
    s_cbranch_vccz L4_got8
    buffer_load_dword v123, v3, s[32:35], s75 offen offset:256 sc1
    s_sub_u32 s49, s49, 1
    s_cbranch_scc1 L4_sgot8
    s_waitcnt vmcnt(0)
    v_cmp_ne_u32 vcc, s72, v123
    s_cbranch_vccnz L4_spoll8
L4_sgot8:
    s_mov_b32 s48, 1
    s_waitcnt vmcnt(0)
    buffer_inv sc1
    s_waitcnt vmcnt(0)
    s_branch L4_got8
L4_wait9:
    s_cmp_lg_u32 s48, 0
    s_cbranch_scc1 L4_slow9
    s_movk_i32 s49, 200
L4_poll9:
    buffer_load_dword v123, v122, s[32:35], s45 offen offset:288 sc1
    s_sub_u32 s49, s49, 1
    s_cbranch_scc1 L4_slow9
    s_waitcnt vmcnt(0)
    v_cmp_ne_u32 vcc, s46, v123
    s_cbranch_vccnz L4_poll9
    s_branch L4_got9
L4_slow9:
    s_waitcnt vmcnt(0)
    buffer_wbl2 sc1
    s_waitcnt vmcnt(0)
    v_mov_b32 v123, 1
    s_add_u32 s74, s44, 32768
    s_add_u32 s75, s45, 32768
    buffer_store_byte v123, off, s[32:35], s74 offset:288 sc1
    s_mov_b32 s49, 200000
L4_spoll9:
    s_waitcnt vmcnt(0)
    buffer_load_dword v123, v122, s[32:35], s45 offen offset:288 sc1
    s_waitcnt vmcnt(0)
    v_cmp_ne_u32 vcc, s46, v123
    s_cbranch_vccz L4_got9
    buffer_load_dword v123, v122, s[32:35], s75 offen offset:288 sc1
    s_sub_u32 s49, s49, 1
    s_cbranch_scc1 L4_sgot9
    s_waitcnt vmcnt(0)
    v_cmp_ne_u32 vcc, s72, v123
    s_cbranch_vccnz L4_spoll9
L4_sgot9:
    s_mov_b32 s48, 1
    s_waitcnt vmcnt(0)
    buffer_inv sc1
    s_waitcnt vmcnt(0)
    s_branch L4_got9
L3_codeend:
.section .rodata,"a"
.p2align 6
.amdhsa_kernel interleave_layers__ssm_conv_h3__dense_activation_silu__prompt_kernel
  .amdhsa_next_free_vgpr 512
  .amdhsa_next_free_sgpr 102
  .amdhsa_accum_offset 256
  .amdhsa_group_segment_fixed_size 0
  .amdhsa_kernarg_size 96
  .amdhsa_user_sgpr_count 2
  .amdhsa_user_sgpr_kernarg_segment_ptr 1
  .amdhsa_system_sgpr_workgroup_id_x 1
  .amdhsa_float_denorm_mode_32 3
.end_amdhsa_kernel
.text
```
